```python
import torch

def _softmax(x, axis=-1):
    return torch.softmax(x, dim=axis)
def _gelu(x):
    return torch.nn.functional.gelu(x, approximate="tanh")
def _silu(x):
    return torch.nn.functional.silu(x)
def _sigmoid(x):
    return torch.sigmoid(x)
def _layernorm(x, axis=-1, eps=1e-5):
    m = x.mean(dim=axis, keepdim=True)
    v = x.var(dim=axis, keepdim=True, unbiased=False)
    return (x - m) / torch.sqrt(v + eps)
def _scatter_add(tgt, idx, src, axis=0):
    return tgt.clone().index_add_(axis, idx, src)
def _segment_sum(src, seg, n):
    out = torch.zeros((n,) + src.shape[1:], dtype=src.dtype)
    return out.index_add_(0, seg, src)
def _pad(x, pw):
    flat = tuple(v for pair in reversed(pw) for v in pair)
    return torch.nn.functional.pad(x, flat)

kernel_name = 'gather_scatter__cheap_equivariant_egnn__graph'

def setup_inputs():

    _w = (lambda a: (lambda t: t.to(torch.bfloat16) if t.is_floating_point() else t)(torch.as_tensor(a)))
    N, deg, D, De = 10000, 16, 256, max(16, 1)
    E = N * deg
    return {
        "h": _w((lambda *s: torch.randn(*s, dtype=torch.bfloat16) * 0.1)(N, D)),
        "pos": _w((lambda *s: torch.randn(*s, dtype=torch.bfloat16) * 0.8)(N, 3)),
        "e_attr": _w((lambda *s: torch.randn(*s, dtype=torch.bfloat16) * 0.8)(E, De)),
        "src": _w((lambda lo, hi, *s: torch.randint(lo, hi, s))(0, N, E).to(torch.int64)),
        "dst": _w((lambda lo, hi, *s: torch.randint(lo, hi, s))(0, N, E).to(torch.int64)),
        "w_e": _w(0.1 * (lambda *s: torch.randn(*s, dtype=torch.bfloat16) * 0.8)(2 * D + 1 + De, D)),
        "w_x": _w(0.1 * (lambda *s: torch.randn(*s, dtype=torch.bfloat16) * 0.1)(D, 1)),
        "w_h": _w(0.1 * (lambda *s: torch.randn(*s, dtype=torch.bfloat16) * 0.1)(2 * D, D)),
    }

def reference(h, pos, e_attr, src, dst, w_e, w_x, w_h):
    N, D = h.shape[0], h.shape[1]
    diff = pos[dst] - pos[src]
    dist2 = torch.sum(diff * diff, axis=-1, keepdims=True)
    e_in = torch.concatenate([h[dst], h[src], dist2, e_attr], axis=-1)
    m_ij = _silu(e_in @ w_e)
    coord_scale = m_ij @ w_x
    pos_new = pos + _segment_sum(diff * coord_scale, dst, N)
    m_i = _segment_sum(m_ij, dst, N)
    h_new = h + _silu(torch.concatenate([h, m_i], axis=-1) @ w_h)
    return h_new, pos_new
```

```asm
; @launch kernel=egnn_k1_kernel grid=(247,1,1) block=(512,1,1) lds=135168
; @launch kernel=egnn_k2_kernel grid=(250,1,1) block=(1024,1,1) lds=156224
.amdgcn_target "amdgcn-amd-amdhsa--gfx950"
.text
.globl egnn_k1_kernel
.p2align 8
.type egnn_k1_kernel,@function
egnn_k1_kernel:
  s_cmp_ge_u32 s2, 247
  s_cbranch_scc1 K1_END
  s_load_dwordx16 s[4:19], s[0:1], 0
  s_load_dwordx2 s[24:25], s[0:1], 80
  s_cmp_ge_u32 s2, 64
  s_cbranch_scc1 K1_NOTPROD
  v_lshlrev_b32 v1, 2, v0
  v_mov_b32 v2, 0
  ds_write_b32 v1, v2
  s_mul_i32 s44, s2, 10000
  s_movk_i32 s45, 4096
  s_movk_i32 s46, 8192
  v_add_u32 v3, s44, v1
  s_waitcnt lgkmcnt(0)
  s_mov_b32 s28, s12
  s_and_b32 s29, s13, 0xffff
  s_mov_b32 s30, 640000
  s_mov_b32 s31, 0x00020000
  s_mov_b32 s32, s10
  s_and_b32 s33, s11, 0xffff
  s_mov_b32 s34, 640000
  s_mov_b32 s35, 0x00020000
  buffer_load_dword v10, v3, s[28:31], 0 offen offset:0
  buffer_load_dword v15, v3, s[32:35], 0 offen offset:0
  buffer_load_dword v11, v3, s[28:31], 0 offen offset:2048
  buffer_load_dword v16, v3, s[32:35], 0 offen offset:2048
  buffer_load_dword v12, v3, s[28:31], s45 offen offset:0
  buffer_load_dword v17, v3, s[32:35], s45 offen offset:0
  buffer_load_dword v13, v3, s[28:31], s45 offen offset:2048
  buffer_load_dword v18, v3, s[32:35], s45 offen offset:2048
  buffer_load_dword v14, v3, s[28:31], s46 offen offset:0
  buffer_load_dword v19, v3, s[32:35], s46 offen offset:0
  s_mov_b32 s36, s6
  s_and_b32 s37, s7, 0xffff
  s_mov_b32 s38, 60000
  s_mov_b32 s39, 0x00020000
  s_mov_b32 s40, s24
  s_and_b32 s41, s25, 0xffff
  s_mov_b32 s42, 16777216
  s_mov_b32 s43, 0x00020000
  s_barrier
  v_mov_b32 v4, 1
  v_cmp_gt_u32 vcc, 452, v0
  s_nop 0
  s_mov_b64 s[48:49], vcc
  s_mul_i32 s51, s2, 2500
  s_waitcnt vmcnt(8)
  v_mul_u32_u24 v5, 6, v10
  v_mul_u32_u24 v6, 6, v15
  v_and_b32 v56, 2, v5
  v_and_b32 v61, 2, v6
  v_and_b32 v5, -4, v5
  v_and_b32 v6, -4, v6
  buffer_load_dwordx2 v[36:37], v5, s[36:39], 0 offen
  buffer_load_dwordx2 v[46:47], v6, s[36:39], 0 offen
  v_mul_u32_u24 v20, 52429, v10
  v_lshrrev_b32 v20, 21, v20
  v_mul_u32_u24 v7, 40, v20
  v_sub_u32 v7, v10, v7
  v_lshlrev_b32 v76, 9, v15
  v_lshl_or_b32 v76, v7, 24, v76
  v_or_b32 v76, v76, v20
  v_add_u32 v77, s51, v0
  v_lshlrev_b32 v77, 5, v77
  v_lshlrev_b32 v7, 2, v20
  ds_add_rtn_u32 v30, v7, v4
  s_waitcnt vmcnt(8)
  v_mul_u32_u24 v5, 6, v11
  v_mul_u32_u24 v6, 6, v16
  v_and_b32 v57, 2, v5
  v_and_b32 v62, 2, v6
  v_and_b32 v5, -4, v5
  v_and_b32 v6, -4, v6
  buffer_load_dwordx2 v[38:39], v5, s[36:39], 0 offen
  buffer_load_dwordx2 v[48:49], v6, s[36:39], 0 offen
  v_mul_u32_u24 v21, 52429, v11
  v_lshrrev_b32 v21, 21, v21
  v_mul_u32_u24 v7, 40, v21
  v_sub_u32 v7, v11, v7
  v_lshlrev_b32 v80, 9, v16
  v_lshl_or_b32 v80, v7, 24, v80
  v_or_b32 v80, v80, v21
  v_add_u32 v81, s51, v0
  v_add_u32 v81, 512, v81
  v_lshlrev_b32 v81, 5, v81
  v_lshlrev_b32 v7, 2, v21
  ds_add_rtn_u32 v31, v7, v4
  s_waitcnt vmcnt(8)
  v_mul_u32_u24 v5, 6, v12
  v_mul_u32_u24 v6, 6, v17
  v_and_b32 v58, 2, v5
  v_and_b32 v63, 2, v6
  v_and_b32 v5, -4, v5
  v_and_b32 v6, -4, v6
  buffer_load_dwordx2 v[40:41], v5, s[36:39], 0 offen
  buffer_load_dwordx2 v[50:51], v6, s[36:39], 0 offen
  v_mul_u32_u24 v22, 52429, v12
  v_lshrrev_b32 v22, 21, v22
  v_mul_u32_u24 v7, 40, v22
  v_sub_u32 v7, v12, v7
  v_lshlrev_b32 v84, 9, v17
  v_lshl_or_b32 v84, v7, 24, v84
  v_or_b32 v84, v84, v22
  v_add_u32 v85, s51, v0
  v_add_u32 v85, 1024, v85
  v_lshlrev_b32 v85, 5, v85
  v_lshlrev_b32 v7, 2, v22
  ds_add_rtn_u32 v32, v7, v4
  s_waitcnt vmcnt(8)
  v_mul_u32_u24 v5, 6, v13
  v_mul_u32_u24 v6, 6, v18
  v_and_b32 v59, 2, v5
  v_and_b32 v64, 2, v6
  v_and_b32 v5, -4, v5
  v_and_b32 v6, -4, v6
  buffer_load_dwordx2 v[42:43], v5, s[36:39], 0 offen
  buffer_load_dwordx2 v[52:53], v6, s[36:39], 0 offen
  v_mul_u32_u24 v23, 52429, v13
  v_lshrrev_b32 v23, 21, v23
  v_mul_u32_u24 v7, 40, v23
  v_sub_u32 v7, v13, v7
  v_lshlrev_b32 v88, 9, v18
  v_lshl_or_b32 v88, v7, 24, v88
  v_or_b32 v88, v88, v23
  v_add_u32 v89, s51, v0
  v_add_u32 v89, 1536, v89
  v_lshlrev_b32 v89, 5, v89
  v_lshlrev_b32 v7, 2, v23
  ds_add_rtn_u32 v33, v7, v4
  s_waitcnt vmcnt(8)
  v_mul_u32_u24 v5, 6, v14
  v_mul_u32_u24 v6, 6, v19
  v_and_b32 v60, 2, v5
  v_and_b32 v65, 2, v6
  v_and_b32 v5, -4, v5
  v_and_b32 v6, -4, v6
  buffer_load_dwordx2 v[44:45], v5, s[36:39], 0 offen
  buffer_load_dwordx2 v[54:55], v6, s[36:39], 0 offen
  v_mul_u32_u24 v24, 52429, v14
  v_lshrrev_b32 v24, 21, v24
  v_mul_u32_u24 v7, 40, v24
  v_sub_u32 v7, v14, v7
  v_lshlrev_b32 v92, 9, v19
  v_lshl_or_b32 v92, v7, 24, v92
  v_or_b32 v92, v92, v24
  v_add_u32 v93, s51, v0
  v_add_u32 v93, 2048, v93
  v_lshlrev_b32 v93, 5, v93
  v_mov_b32 v8, 255
  v_cndmask_b32 v24, v8, v24, s[48:49]
  v_lshlrev_b32 v7, 2, v24
  ds_add_rtn_u32 v34, v7, v4
  s_mul_i32 s52, s2, 40000
  s_add_u32 s52, s52, 13631488
  s_mov_b32 s56, 0xffff0000
  s_waitcnt vmcnt(8)
  v_alignbyte_b32 v5, v37, v36, v56
  v_alignbyte_b32 v6, v37, v37, v56
  v_alignbyte_b32 v7, v47, v46, v61
  v_alignbyte_b32 v8, v47, v47, v61
  v_lshlrev_b32 v101, 16, v5
  v_and_b32 v102, s56, v5
  v_lshlrev_b32 v103, 16, v6
  v_lshlrev_b32 v104, 16, v7
  v_and_b32 v105, s56, v7
  v_lshlrev_b32 v106, 16, v8
  v_sub_f32 v101, v101, v104
  v_sub_f32 v102, v102, v105
  v_sub_f32 v103, v103, v106
  v_cvt_pk_bf16_f32 v78, v101, v102
  v_cvt_pk_bf16_f32 v5, v103, v103
  v_lshlrev_b32 v101, 16, v78
  v_and_b32 v102, s56, v78
  v_lshlrev_b32 v103, 16, v5
  v_mul_f32 v104, v101, v101
  v_mul_f32 v105, v102, v102
  v_mul_f32 v106, v103, v103
  v_cvt_pk_bf16_f32 v5, v104, v105
  v_cvt_pk_bf16_f32 v6, v106, v106
  v_lshlrev_b32 v104, 16, v5
  v_and_b32 v105, s56, v5
  v_lshlrev_b32 v106, 16, v6
  v_add_f32 v104, v104, v105
  v_add_f32 v104, v104, v106
  v_cvt_pk_bf16_f32 v79, v103, v104
  s_waitcnt lgkmcnt(0)
  v_lshlrev_b32 v5, 9, v20
  v_lshl_add_u32 v5, v30, 4, v5
  v_add_u32 v5, 4096, v5
  v_cmp_gt_u32 vcc, 32, v30
  s_nop 0
  s_and_saveexec_b64 s[54:55], vcc
  ds_write_b128 v5, v[76:79]
  s_andn2_b64 exec, s[54:55], exec
  s_cbranch_execz K1P_NOOVF0
  v_mov_b32 v5, 1024
  ds_add_rtn_u32 v6, v5, v4
  s_waitcnt lgkmcnt(0)
  v_lshlrev_b32 v6, 4, v6
  buffer_store_dwordx4 v[76:79], v6, s[40:43], s52 offen
K1P_NOOVF0:
  s_mov_b64 exec, s[54:55]
  s_waitcnt vmcnt(6)
  v_alignbyte_b32 v5, v39, v38, v57
  v_alignbyte_b32 v6, v39, v39, v57
  v_alignbyte_b32 v7, v49, v48, v62
  v_alignbyte_b32 v8, v49, v49, v62
  v_lshlrev_b32 v101, 16, v5
  v_and_b32 v102, s56, v5
  v_lshlrev_b32 v103, 16, v6
  v_lshlrev_b32 v104, 16, v7
  v_and_b32 v105, s56, v7
  v_lshlrev_b32 v106, 16, v8
  v_sub_f32 v101, v101, v104
  v_sub_f32 v102, v102, v105
  v_sub_f32 v103, v103, v106
  v_cvt_pk_bf16_f32 v82, v101, v102
  v_cvt_pk_bf16_f32 v5, v103, v103
  v_lshlrev_b32 v101, 16, v82
  v_and_b32 v102, s56, v82
  v_lshlrev_b32 v103, 16, v5
  v_mul_f32 v104, v101, v101
  v_mul_f32 v105, v102, v102
  v_mul_f32 v106, v103, v103
  v_cvt_pk_bf16_f32 v5, v104, v105
  v_cvt_pk_bf16_f32 v6, v106, v106
  v_lshlrev_b32 v104, 16, v5
  v_and_b32 v105, s56, v5
  v_lshlrev_b32 v106, 16, v6
  v_add_f32 v104, v104, v105
  v_add_f32 v104, v104, v106
  v_cvt_pk_bf16_f32 v83, v103, v104
  v_lshlrev_b32 v5, 9, v21
  v_lshl_add_u32 v5, v31, 4, v5
  v_add_u32 v5, 4096, v5
  v_cmp_gt_u32 vcc, 32, v31
  s_nop 0
  s_and_saveexec_b64 s[54:55], vcc
  ds_write_b128 v5, v[80:83]
  s_andn2_b64 exec, s[54:55], exec
  s_cbranch_execz K1P_NOOVF1
  v_mov_b32 v5, 1024
  ds_add_rtn_u32 v6, v5, v4
  s_waitcnt lgkmcnt(0)
  v_lshlrev_b32 v6, 4, v6
  buffer_store_dwordx4 v[80:83], v6, s[40:43], s52 offen
K1P_NOOVF1:
  s_mov_b64 exec, s[54:55]
  s_waitcnt vmcnt(4)
  v_alignbyte_b32 v5, v41, v40, v58
  v_alignbyte_b32 v6, v41, v41, v58
  v_alignbyte_b32 v7, v51, v50, v63
  v_alignbyte_b32 v8, v51, v51, v63
  v_lshlrev_b32 v101, 16, v5
  v_and_b32 v102, s56, v5
  v_lshlrev_b32 v103, 16, v6
  v_lshlrev_b32 v104, 16, v7
  v_and_b32 v105, s56, v7
  v_lshlrev_b32 v106, 16, v8
  v_sub_f32 v101, v101, v104
  v_sub_f32 v102, v102, v105
  v_sub_f32 v103, v103, v106
  v_cvt_pk_bf16_f32 v86, v101, v102
  v_cvt_pk_bf16_f32 v5, v103, v103
  v_lshlrev_b32 v101, 16, v86
  v_and_b32 v102, s56, v86
  v_lshlrev_b32 v103, 16, v5
  v_mul_f32 v104, v101, v101
  v_mul_f32 v105, v102, v102
  v_mul_f32 v106, v103, v103
  v_cvt_pk_bf16_f32 v5, v104, v105
  v_cvt_pk_bf16_f32 v6, v106, v106
  v_lshlrev_b32 v104, 16, v5
  v_and_b32 v105, s56, v5
  v_lshlrev_b32 v106, 16, v6
  v_add_f32 v104, v104, v105
  v_add_f32 v104, v104, v106
  v_cvt_pk_bf16_f32 v87, v103, v104
  v_lshlrev_b32 v5, 9, v22
  v_lshl_add_u32 v5, v32, 4, v5
  v_add_u32 v5, 4096, v5
  v_cmp_gt_u32 vcc, 32, v32
  s_nop 0
  s_and_saveexec_b64 s[54:55], vcc
  ds_write_b128 v5, v[84:87]
  s_andn2_b64 exec, s[54:55], exec
  s_cbranch_execz K1P_NOOVF2
  v_mov_b32 v5, 1024
  ds_add_rtn_u32 v6, v5, v4
  s_waitcnt lgkmcnt(0)
  v_lshlrev_b32 v6, 4, v6
  buffer_store_dwordx4 v[84:87], v6, s[40:43], s52 offen
K1P_NOOVF2:
  s_mov_b64 exec, s[54:55]
  s_waitcnt vmcnt(2)
  v_alignbyte_b32 v5, v43, v42, v59
  v_alignbyte_b32 v6, v43, v43, v59
  v_alignbyte_b32 v7, v53, v52, v64
  v_alignbyte_b32 v8, v53, v53, v64
  v_lshlrev_b32 v101, 16, v5
  v_and_b32 v102, s56, v5
  v_lshlrev_b32 v103, 16, v6
  v_lshlrev_b32 v104, 16, v7
  v_and_b32 v105, s56, v7
  v_lshlrev_b32 v106, 16, v8
  v_sub_f32 v101, v101, v104
  v_sub_f32 v102, v102, v105
  v_sub_f32 v103, v103, v106
  v_cvt_pk_bf16_f32 v90, v101, v102
  v_cvt_pk_bf16_f32 v5, v103, v103
  v_lshlrev_b32 v101, 16, v90
  v_and_b32 v102, s56, v90
  v_lshlrev_b32 v103, 16, v5
  v_mul_f32 v104, v101, v101
  v_mul_f32 v105, v102, v102
  v_mul_f32 v106, v103, v103
  v_cvt_pk_bf16_f32 v5, v104, v105
  v_cvt_pk_bf16_f32 v6, v106, v106
  v_lshlrev_b32 v104, 16, v5
  v_and_b32 v105, s56, v5
  v_lshlrev_b32 v106, 16, v6
  v_add_f32 v104, v104, v105
  v_add_f32 v104, v104, v106
  v_cvt_pk_bf16_f32 v91, v103, v104
  v_lshlrev_b32 v5, 9, v23
  v_lshl_add_u32 v5, v33, 4, v5
  v_add_u32 v5, 4096, v5
  v_cmp_gt_u32 vcc, 32, v33
  s_nop 0
  s_and_saveexec_b64 s[54:55], vcc
  ds_write_b128 v5, v[88:91]
  s_andn2_b64 exec, s[54:55], exec
  s_cbranch_execz K1P_NOOVF3
  v_mov_b32 v5, 1024
  ds_add_rtn_u32 v6, v5, v4
  s_waitcnt lgkmcnt(0)
  v_lshlrev_b32 v6, 4, v6
  buffer_store_dwordx4 v[88:91], v6, s[40:43], s52 offen
K1P_NOOVF3:
  s_mov_b64 exec, s[54:55]
  s_waitcnt vmcnt(0)
  v_alignbyte_b32 v5, v45, v44, v60
  v_alignbyte_b32 v6, v45, v45, v60
  v_alignbyte_b32 v7, v55, v54, v65
  v_alignbyte_b32 v8, v55, v55, v65
  v_lshlrev_b32 v101, 16, v5
  v_and_b32 v102, s56, v5
  v_lshlrev_b32 v103, 16, v6
  v_lshlrev_b32 v104, 16, v7
  v_and_b32 v105, s56, v7
  v_lshlrev_b32 v106, 16, v8
  v_sub_f32 v101, v101, v104
  v_sub_f32 v102, v102, v105
  v_sub_f32 v103, v103, v106
  v_cvt_pk_bf16_f32 v94, v101, v102
  v_cvt_pk_bf16_f32 v5, v103, v103
  v_lshlrev_b32 v101, 16, v94
  v_and_b32 v102, s56, v94
  v_lshlrev_b32 v103, 16, v5
  v_mul_f32 v104, v101, v101
  v_mul_f32 v105, v102, v102
  v_mul_f32 v106, v103, v103
  v_cvt_pk_bf16_f32 v5, v104, v105
  v_cvt_pk_bf16_f32 v6, v106, v106
  v_lshlrev_b32 v104, 16, v5
  v_and_b32 v105, s56, v5
  v_lshlrev_b32 v106, 16, v6
  v_add_f32 v104, v104, v105
  v_add_f32 v104, v104, v106
  v_cvt_pk_bf16_f32 v95, v103, v104
  v_lshlrev_b32 v5, 9, v24
  v_lshl_add_u32 v5, v34, 4, v5
  v_add_u32 v5, 4096, v5
  v_cmp_gt_u32 vcc, 32, v34
  s_nop 0
  s_and_saveexec_b64 s[54:55], vcc
  ds_write_b128 v5, v[92:95]
  s_andn2_b64 exec, s[54:55], exec
  s_and_b64 exec, exec, s[48:49]
  s_cbranch_execz K1P_NOOVF4
  v_mov_b32 v5, 1024
  ds_add_rtn_u32 v6, v5, v4
  s_waitcnt lgkmcnt(0)
  v_lshlrev_b32 v6, 4, v6
  buffer_store_dwordx4 v[92:95], v6, s[40:43], s52 offen
K1P_NOOVF4:
  s_mov_b64 exec, s[54:55]
  s_waitcnt lgkmcnt(0)
  s_barrier
  v_lshrrev_b32 v5, 4, v0
  v_and_b32 v6, 15, v0
  v_lshlrev_b32 v7, 9, v5
  v_lshl_add_u32 v7, v6, 4, v7
  v_add_u32 v7, 4096, v7
  v_lshlrev_b32 v8, 2, v5
  v_add_u32 v53, 65536, v7
  ds_read_b128 v[12:15], v7 offset:0
  ds_read_b128 v[16:19], v7 offset:16384
  ds_read_b128 v[20:23], v7 offset:32768
  ds_read_b128 v[24:27], v7 offset:49152
  ds_read_b128 v[28:31], v53 offset:0
  ds_read_b128 v[32:35], v53 offset:16384
  ds_read_b128 v[36:39], v53 offset:32768
  ds_read_b128 v[40:43], v53 offset:49152
  ds_read_b32 v44, v8 offset:0
  ds_read_b32 v45, v8 offset:128
  ds_read_b32 v46, v8 offset:256
  ds_read_b32 v47, v8 offset:384
  ds_read_b32 v48, v8 offset:512
  ds_read_b32 v49, v8 offset:640
  ds_read_b32 v50, v8 offset:768
  ds_read_b32 v51, v8 offset:896
  ds_read_b32 v52, v1
  v_lshlrev_b32 v9, 15, v5
  v_lshl_add_u32 v9, v6, 4, v9
  s_lshl_b32 s50, s2, 8
  s_add_u32 s50, s50, 5242880
  s_waitcnt lgkmcnt(15)
  s_add_u32 s53, s50, 0
  buffer_store_dwordx4 v[12:15], v9, s[40:43], s53 offen nt
  s_waitcnt lgkmcnt(15)
  s_add_u32 s53, s50, 1048576
  buffer_store_dwordx4 v[16:19], v9, s[40:43], s53 offen nt
  s_waitcnt lgkmcnt(14)
  s_add_u32 s53, s50, 2097152
  buffer_store_dwordx4 v[20:23], v9, s[40:43], s53 offen nt
  s_waitcnt lgkmcnt(13)
  s_add_u32 s53, s50, 3145728
  buffer_store_dwordx4 v[24:27], v9, s[40:43], s53 offen nt
  s_waitcnt lgkmcnt(12)
  s_add_u32 s53, s50, 4194304
  buffer_store_dwordx4 v[28:31], v9, s[40:43], s53 offen nt
  s_waitcnt lgkmcnt(11)
  s_add_u32 s53, s50, 5242880
  buffer_store_dwordx4 v[32:35], v9, s[40:43], s53 offen nt
  s_waitcnt lgkmcnt(10)
  s_add_u32 s53, s50, 6291456
  buffer_store_dwordx4 v[36:39], v9, s[40:43], s53 offen nt
  s_waitcnt lgkmcnt(9)
  s_add_u32 s53, s50, 7340032
  v_cmp_gt_u32 vcc, 26, v5
  s_nop 0
  s_and_saveexec_b64 s[54:55], vcc
  buffer_store_dwordx4 v[40:43], v9, s[40:43], s53 offen nt
  s_mov_b64 exec, s[54:55]
  s_waitcnt lgkmcnt(0)
  v_cmp_lt_u32 vcc, 16, v44
  s_nop 0
  s_and_saveexec_b64 s[54:55], vcc
  s_cbranch_execz K1P_NO20
  ds_read_b128 v[56:59], v7 offset:256
  s_add_u32 s53, s50, 16384
  s_waitcnt lgkmcnt(0)
  buffer_store_dwordx4 v[56:59], v9, s[40:43], s53 offen
K1P_NO20:
  s_mov_b64 exec, s[54:55]
  v_cmp_lt_u32 vcc, 16, v45
  s_nop 0
  s_and_saveexec_b64 s[54:55], vcc
  s_cbranch_execz K1P_NO21
  ds_read_b128 v[56:59], v7 offset:16640
  s_add_u32 s53, s50, 1064960
  s_waitcnt lgkmcnt(0)
  buffer_store_dwordx4 v[56:59], v9, s[40:43], s53 offen
K1P_NO21:
  s_mov_b64 exec, s[54:55]
  v_cmp_lt_u32 vcc, 16, v46
  s_nop 0
  s_and_saveexec_b64 s[54:55], vcc
  s_cbranch_execz K1P_NO22
  ds_read_b128 v[56:59], v7 offset:33024
  s_add_u32 s53, s50, 2113536
  s_waitcnt lgkmcnt(0)
  buffer_store_dwordx4 v[56:59], v9, s[40:43], s53 offen
K1P_NO22:
  s_mov_b64 exec, s[54:55]
  v_cmp_lt_u32 vcc, 16, v47
  s_nop 0
  s_and_saveexec_b64 s[54:55], vcc
  s_cbranch_execz K1P_NO23
  ds_read_b128 v[56:59], v7 offset:49408
  s_add_u32 s53, s50, 3162112
  s_waitcnt lgkmcnt(0)
  buffer_store_dwordx4 v[56:59], v9, s[40:43], s53 offen
K1P_NO23:
  s_mov_b64 exec, s[54:55]
  v_cmp_lt_u32 vcc, 16, v48
  s_nop 0
  s_and_saveexec_b64 s[54:55], vcc
  s_cbranch_execz K1P_NO24
  ds_read_b128 v[56:59], v53 offset:256
  s_add_u32 s53, s50, 4210688
  s_waitcnt lgkmcnt(0)
  buffer_store_dwordx4 v[56:59], v9, s[40:43], s53 offen
K1P_NO24:
  s_mov_b64 exec, s[54:55]
  v_cmp_lt_u32 vcc, 16, v49
  s_nop 0
  s_and_saveexec_b64 s[54:55], vcc
  s_cbranch_execz K1P_NO25
  ds_read_b128 v[56:59], v53 offset:16640
  s_add_u32 s53, s50, 5259264
  s_waitcnt lgkmcnt(0)
  buffer_store_dwordx4 v[56:59], v9, s[40:43], s53 offen
K1P_NO25:
  s_mov_b64 exec, s[54:55]
  v_cmp_lt_u32 vcc, 16, v50
  s_nop 0
  s_and_saveexec_b64 s[54:55], vcc
  s_cbranch_execz K1P_NO26
  ds_read_b128 v[56:59], v53 offset:33024
  s_add_u32 s53, s50, 6307840
  s_waitcnt lgkmcnt(0)
  buffer_store_dwordx4 v[56:59], v9, s[40:43], s53 offen
K1P_NO26:
  s_mov_b64 exec, s[54:55]
  v_cmp_lt_u32 vcc, 16, v51
  v_cmp_gt_u32 s[56:57], 26, v5
  s_nop 0
  s_and_b64 vcc, vcc, s[56:57]
  s_and_saveexec_b64 s[54:55], vcc
  s_cbranch_execz K1P_NO27
  ds_read_b128 v[56:59], v53 offset:49408
  s_add_u32 s53, s50, 7356416
  s_waitcnt lgkmcnt(0)
  buffer_store_dwordx4 v[56:59], v9, s[40:43], s53 offen
K1P_NO27:
  s_mov_b64 exec, s[54:55]
  s_lshl_b32 s50, s2, 2
  s_add_u32 s51, s50, 13434880
  s_add_u32 s52, s50, 13500416
  v_lshlrev_b32 v6, 8, v0
  v_add_u32 v6, s51, v6
  v_mov_b32 v7, 0x7ffffff0
  v_cmp_gt_u32 vcc, 250, v0
  s_nop 1
  v_cndmask_b32 v6, v7, v6, vcc
  v_mov_b32 v7, s52
  v_cmp_eq_u32 vcc, 256, v0
  s_nop 1
  v_cndmask_b32 v6, v6, v7, vcc
  buffer_store_dword v52, v6, s[40:43], 0 offen
  s_endpgm
K1_NOTPROD:
  s_cmp_ge_u32 s2, 222
  s_cbranch_scc1 K1_IMG
  s_sub_u32 s26, s2, 64
  s_lshr_b32 s27, s26, 1
  s_and_b32 s26, s26, 1
  v_lshrrev_b32 v1, 6, v0
  v_and_b32 v2, 63, v0
  v_readfirstlane_b32 s44, v1
  v_and_b32 v3, 31, v2
  v_lshrrev_b32 v4, 5, v2
  v_xor_b32 v5, v3, v4
  v_lshlrev_b32 v5, 4, v5
  v_lshl_or_b32 v5, v4, 9, v5
  s_lshl_b32 s45, s27, 16
  s_lshl_b32 s46, s44, 13
  s_add_u32 s45, s45, s46
  s_and_b32 s48, s44, 3
  s_lshr_b32 s49, s44, 2
  s_lshl_b32 s50, s26, 1
  s_add_u32 s50, s50, s49
  v_and_b32 v6, 7, v2
  v_lshrrev_b32 v7, 3, v2
  v_lshlrev_b32 v8, 12, v7
  v_lshl_add_u32 v8, v6, 4, v8
  s_lshl_b32 s51, s50, 7
  s_lshl_b32 s52, s48, 15
  s_add_u32 s52, s52, s51
  s_waitcnt lgkmcnt(0)
  s_mov_b32 s32, s14
  s_and_b32 s33, s15, 0xffff
  s_mov_b32 s34, 270848
  s_mov_b32 s35, 0x00020000
  s_add_u32 s53, s52, 131072
  buffer_load_dwordx4 v[16:19], v8, s[32:35], s53 offen offset:0
  buffer_load_dwordx4 v[20:23], v8, s[32:35], s53 offen offset:512
  buffer_load_dwordx4 v[24:27], v8, s[32:35], s53 offen offset:1024
  buffer_load_dwordx4 v[28:31], v8, s[32:35], s53 offen offset:1536
  buffer_load_dwordx4 v[32:35], v8, s[32:35], s53 offen offset:2048
  buffer_load_dwordx4 v[36:39], v8, s[32:35], s53 offen offset:2560
  buffer_load_dwordx4 v[40:43], v8, s[32:35], s53 offen offset:3072
  buffer_load_dwordx4 v[44:47], v8, s[32:35], s53 offen offset:3584
  s_mov_b32 s28, s4
  s_and_b32 s29, s5, 0xffff
  s_mov_b32 s30, 5120000
  s_mov_b32 s31, 0x00020000
  v_xor_b32 v9, 0, v5
  s_add_u32 s47, s45, 0
  s_add_u32 m0, s46, 0
  s_nop 0
  buffer_load_dwordx4 v9, s[28:31], s47 offen lds
  v_xor_b32 v9, 32, v5
  s_add_u32 s47, s45, 1024
  s_add_u32 m0, s46, 1024
  s_nop 0
  buffer_load_dwordx4 v9, s[28:31], s47 offen lds
  v_xor_b32 v9, 64, v5
  s_add_u32 s47, s45, 2048
  s_add_u32 m0, s46, 2048
  s_nop 0
  buffer_load_dwordx4 v9, s[28:31], s47 offen lds
  v_xor_b32 v9, 96, v5
  s_add_u32 s47, s45, 3072
  s_add_u32 m0, s46, 3072
  s_nop 0
  buffer_load_dwordx4 v9, s[28:31], s47 offen lds
  v_xor_b32 v9, 128, v5
  s_add_u32 s47, s45, 4096
  s_add_u32 m0, s46, 4096
  s_nop 0
  buffer_load_dwordx4 v9, s[28:31], s47 offen lds
  v_xor_b32 v9, 160, v5
  s_add_u32 s47, s45, 5120
  s_add_u32 m0, s46, 5120
  s_nop 0
  buffer_load_dwordx4 v9, s[28:31], s47 offen lds
  v_xor_b32 v9, 192, v5
  s_add_u32 s47, s45, 6144
  s_add_u32 m0, s46, 6144
  s_nop 0
  buffer_load_dwordx4 v9, s[28:31], s47 offen lds
  v_xor_b32 v9, 224, v5
  s_add_u32 s47, s45, 7168
  s_add_u32 m0, s46, 7168
  s_nop 0
  buffer_load_dwordx4 v9, s[28:31], s47 offen lds
  s_mov_b32 s36, s24
  s_and_b32 s37, s25, 0xffff
  s_mov_b32 s38, 5120000
  s_mov_b32 s39, 0x00020000
  s_mov_b32 s54, 0x05040100
  s_mov_b32 s55, 0x07060302
  v_lshrrev_b32 v10, 1, v7
  v_lshlrev_b32 v10, 11, v10
  v_and_b32 v11, 1, v7
  v_lshl_add_u32 v10, v11, 9, v10
  v_lshl_add_u32 v10, v6, 6, v10
  s_lshl_b32 s56, s49, 15
  s_lshl_b32 s57, s48, 13
  s_add_u32 s56, s56, s57
  s_add_u32 s56, s56, 65536
  v_add_u32 v9, s56, v10
  s_waitcnt vmcnt(8)
  v_perm_b32 v48, v20, v16, s54
  v_perm_b32 v52, v20, v16, s55
  v_perm_b32 v49, v28, v24, s54
  v_perm_b32 v53, v28, v24, s55
  v_perm_b32 v50, v36, v32, s54
  v_perm_b32 v54, v36, v32, s55
  v_perm_b32 v51, v44, v40, s54
  v_perm_b32 v55, v44, v40, s55
  ds_write_b128 v9, v[48:51] offset:0
  ds_write_b128 v9, v[52:55] offset:1024
  v_perm_b32 v48, v21, v17, s54
  v_perm_b32 v52, v21, v17, s55
  v_perm_b32 v49, v29, v25, s54
  v_perm_b32 v53, v29, v25, s55
  v_perm_b32 v50, v37, v33, s54
  v_perm_b32 v54, v37, v33, s55
  v_perm_b32 v51, v45, v41, s54
  v_perm_b32 v55, v45, v41, s55
  ds_write_b128 v9, v[48:51] offset:16
  ds_write_b128 v9, v[52:55] offset:1040
  v_perm_b32 v48, v22, v18, s54
  v_perm_b32 v52, v22, v18, s55
  v_perm_b32 v49, v30, v26, s54
  v_perm_b32 v53, v30, v26, s55
  v_perm_b32 v50, v38, v34, s54
  v_perm_b32 v54, v38, v34, s55
  v_perm_b32 v51, v46, v42, s54
  v_perm_b32 v55, v46, v42, s55
  ds_write_b128 v9, v[48:51] offset:32
  ds_write_b128 v9, v[52:55] offset:1056
  v_perm_b32 v48, v23, v19, s54
  v_perm_b32 v52, v23, v19, s55
  v_perm_b32 v49, v31, v27, s54
  v_perm_b32 v53, v31, v27, s55
  v_perm_b32 v50, v39, v35, s54
  v_perm_b32 v54, v39, v35, s55
  v_perm_b32 v51, v47, v43, s54
  v_perm_b32 v55, v47, v43, s55
  ds_write_b128 v9, v[48:51] offset:48
  ds_write_b128 v9, v[52:55] offset:1072
  v_and_b32 v10, 15, v3
  v_xor_b32 v10, v10, v4
  v_lshlrev_b32 v10, 4, v10
  v_lshl_add_u32 v10, v3, 9, v10
  s_lshl_b32 s57, s48, 14
  v_add_u32 v10, s57, v10
  v_lshlrev_b32 v8, 4, v2
  s_lshl_b32 s56, s49, 15
  s_add_u32 s56, s56, 65536
  v_add_u32 v11, s56, v8
  s_waitcnt vmcnt(0) lgkmcnt(0)
  s_barrier
  v_xor_b32 v12, 0, v10
  ds_read_b128 v[16:19], v12
  ds_read_b128 v[20:23], v11 offset:0
  ds_read_b128 v[24:27], v11 offset:1024
  v_xor_b32 v12, 32, v10
  ds_read_b128 v[28:31], v12
  ds_read_b128 v[32:35], v11 offset:2048
  ds_read_b128 v[36:39], v11 offset:3072
  v_xor_b32 v12, 64, v10
  ds_read_b128 v[40:43], v12
  ds_read_b128 v[44:47], v11 offset:4096
  ds_read_b128 v[48:51], v11 offset:5120
  v_xor_b32 v12, 96, v10
  ds_read_b128 v[52:55], v12
  ds_read_b128 v[56:59], v11 offset:6144
  ds_read_b128 v[60:63], v11 offset:7168
  s_waitcnt lgkmcnt(9)
  v_mfma_f32_32x32x16_bf16 v[64:79], v[16:19], v[20:23], 0
  v_mfma_f32_32x32x16_bf16 v[80:95], v[16:19], v[24:27], 0
  v_xor_b32 v12, 128, v10
  ds_read_b128 v[16:19], v12
  ds_read_b128 v[20:23], v11 offset:8192
  ds_read_b128 v[24:27], v11 offset:9216
  s_waitcnt lgkmcnt(9)
  v_mfma_f32_32x32x16_bf16 v[64:79], v[28:31], v[32:35], v[64:79]
  v_mfma_f32_32x32x16_bf16 v[80:95], v[28:31], v[36:39], v[80:95]
  v_xor_b32 v12, 160, v10
  ds_read_b128 v[28:31], v12
  ds_read_b128 v[32:35], v11 offset:10240
  ds_read_b128 v[36:39], v11 offset:11264
  s_waitcnt lgkmcnt(9)
  v_mfma_f32_32x32x16_bf16 v[64:79], v[40:43], v[44:47], v[64:79]
  v_mfma_f32_32x32x16_bf16 v[80:95], v[40:43], v[48:51], v[80:95]
  v_xor_b32 v12, 192, v10
  ds_read_b128 v[40:43], v12
  ds_read_b128 v[44:47], v11 offset:12288
  ds_read_b128 v[48:51], v11 offset:13312
  s_waitcnt lgkmcnt(9)
  v_mfma_f32_32x32x16_bf16 v[64:79], v[52:55], v[56:59], v[64:79]
  v_mfma_f32_32x32x16_bf16 v[80:95], v[52:55], v[60:63], v[80:95]
  v_xor_b32 v12, 224, v10
  ds_read_b128 v[52:55], v12
  ds_read_b128 v[56:59], v11 offset:14336
  ds_read_b128 v[60:63], v11 offset:15360
  s_waitcnt lgkmcnt(9)
  v_mfma_f32_32x32x16_bf16 v[64:79], v[16:19], v[20:23], v[64:79]
  v_mfma_f32_32x32x16_bf16 v[80:95], v[16:19], v[24:27], v[80:95]
  v_xor_b32 v12, 256, v10
  ds_read_b128 v[16:19], v12
  ds_read_b128 v[20:23], v11 offset:16384
  ds_read_b128 v[24:27], v11 offset:17408
  s_waitcnt lgkmcnt(9)
  v_mfma_f32_32x32x16_bf16 v[64:79], v[28:31], v[32:35], v[64:79]
  v_mfma_f32_32x32x16_bf16 v[80:95], v[28:31], v[36:39], v[80:95]
  v_xor_b32 v12, 288, v10
  ds_read_b128 v[28:31], v12
  ds_read_b128 v[32:35], v11 offset:18432
  ds_read_b128 v[36:39], v11 offset:19456
  s_waitcnt lgkmcnt(9)
  v_mfma_f32_32x32x16_bf16 v[64:79], v[40:43], v[44:47], v[64:79]
  v_mfma_f32_32x32x16_bf16 v[80:95], v[40:43], v[48:51], v[80:95]
  v_xor_b32 v12, 320, v10
  ds_read_b128 v[40:43], v12
  ds_read_b128 v[44:47], v11 offset:20480
  ds_read_b128 v[48:51], v11 offset:21504
  s_waitcnt lgkmcnt(9)
  v_mfma_f32_32x32x16_bf16 v[64:79], v[52:55], v[56:59], v[64:79]
  v_mfma_f32_32x32x16_bf16 v[80:95], v[52:55], v[60:63], v[80:95]
  v_xor_b32 v12, 352, v10
  ds_read_b128 v[52:55], v12
  ds_read_b128 v[56:59], v11 offset:22528
  ds_read_b128 v[60:63], v11 offset:23552
  s_waitcnt lgkmcnt(9)
  v_mfma_f32_32x32x16_bf16 v[64:79], v[16:19], v[20:23], v[64:79]
  v_mfma_f32_32x32x16_bf16 v[80:95], v[16:19], v[24:27], v[80:95]
  v_xor_b32 v12, 384, v10
  ds_read_b128 v[16:19], v12
  ds_read_b128 v[20:23], v11 offset:24576
  ds_read_b128 v[24:27], v11 offset:25600
  s_waitcnt lgkmcnt(9)
  v_mfma_f32_32x32x16_bf16 v[64:79], v[28:31], v[32:35], v[64:79]
  v_mfma_f32_32x32x16_bf16 v[80:95], v[28:31], v[36:39], v[80:95]
  v_xor_b32 v12, 416, v10
  ds_read_b128 v[28:31], v12
  ds_read_b128 v[32:35], v11 offset:26624
  ds_read_b128 v[36:39], v11 offset:27648
  s_waitcnt lgkmcnt(9)
  v_mfma_f32_32x32x16_bf16 v[64:79], v[40:43], v[44:47], v[64:79]
  v_mfma_f32_32x32x16_bf16 v[80:95], v[40:43], v[48:51], v[80:95]
  v_xor_b32 v12, 448, v10
  ds_read_b128 v[40:43], v12
  ds_read_b128 v[44:47], v11 offset:28672
  ds_read_b128 v[48:51], v11 offset:29696
  s_waitcnt lgkmcnt(9)
  v_mfma_f32_32x32x16_bf16 v[64:79], v[52:55], v[56:59], v[64:79]
  v_mfma_f32_32x32x16_bf16 v[80:95], v[52:55], v[60:63], v[80:95]
  v_xor_b32 v12, 480, v10
  ds_read_b128 v[52:55], v12
  ds_read_b128 v[56:59], v11 offset:30720
  ds_read_b128 v[60:63], v11 offset:31744
  s_waitcnt lgkmcnt(9)
  v_mfma_f32_32x32x16_bf16 v[64:79], v[16:19], v[20:23], v[64:79]
  v_mfma_f32_32x32x16_bf16 v[80:95], v[16:19], v[24:27], v[80:95]
  s_waitcnt lgkmcnt(6)
  v_mfma_f32_32x32x16_bf16 v[64:79], v[28:31], v[32:35], v[64:79]
  v_mfma_f32_32x32x16_bf16 v[80:95], v[28:31], v[36:39], v[80:95]
  s_waitcnt lgkmcnt(3)
  v_mfma_f32_32x32x16_bf16 v[64:79], v[40:43], v[44:47], v[64:79]
  v_mfma_f32_32x32x16_bf16 v[80:95], v[40:43], v[48:51], v[80:95]
  s_waitcnt lgkmcnt(0)
  v_mfma_f32_32x32x16_bf16 v[64:79], v[52:55], v[56:59], v[64:79]
  v_mfma_f32_32x32x16_bf16 v[80:95], v[52:55], v[60:63], v[80:95]
  s_mov_b32 s58, 3216550459
  s_mov_b32 s59, 0x7f7fffff
  s_mov_b32 s60, 0xffff0000
  s_mov_b32 s61, 0x80000000
  v_lshlrev_b32 v13, 11, v4
  v_lshl_add_u32 v13, v3, 2, v13
  s_lshl_b32 s62, s27, 16
  s_lshl_b32 s63, s48, 14
  s_add_u32 s62, s62, s63
  s_lshl_b32 s63, s50, 7
  s_add_u32 s62, s62, s63
  v_mul_f32 v16, s58, v64
  v_mul_f32 v17, s58, v80
  v_cvt_pk_bf16_f32 v18, v16, v16
  v_and_b32 v19, 0x7fffffff, v17
  v_and_b32 v18, 0xffff, v18
  v_add_u32 v19, 0x8000, v19
  v_sub_u32 v19, v19, v18
  v_med3_i32 v19, v19, 0, s59
  v_and_or_b32 v19, v19, s60, v18
  v_and_or_b32 v20, v17, s61, v19
  s_add_u32 s63, s62, 0
  buffer_store_dword v20, v13, s[36:39], s63 offen offset:0 nt
  v_mul_f32 v16, s58, v65
  v_mul_f32 v17, s58, v81
  v_cvt_pk_bf16_f32 v18, v16, v16
  v_and_b32 v19, 0x7fffffff, v17
  v_and_b32 v18, 0xffff, v18
  v_add_u32 v19, 0x8000, v19
  v_sub_u32 v19, v19, v18
  v_med3_i32 v19, v19, 0, s59
  v_and_or_b32 v19, v19, s60, v18
  v_and_or_b32 v21, v17, s61, v19
  buffer_store_dword v21, v13, s[36:39], s63 offen offset:512 nt
  v_mul_f32 v16, s58, v66
  v_mul_f32 v17, s58, v82
  v_cvt_pk_bf16_f32 v18, v16, v16
  v_and_b32 v19, 0x7fffffff, v17
  v_and_b32 v18, 0xffff, v18
  v_add_u32 v19, 0x8000, v19
  v_sub_u32 v19, v19, v18
  v_med3_i32 v19, v19, 0, s59
  v_and_or_b32 v19, v19, s60, v18
  v_and_or_b32 v22, v17, s61, v19
  buffer_store_dword v22, v13, s[36:39], s63 offen offset:1024 nt
  v_mul_f32 v16, s58, v67
  v_mul_f32 v17, s58, v83
  v_cvt_pk_bf16_f32 v18, v16, v16
  v_and_b32 v19, 0x7fffffff, v17
  v_and_b32 v18, 0xffff, v18
  v_add_u32 v19, 0x8000, v19
  v_sub_u32 v19, v19, v18
  v_med3_i32 v19, v19, 0, s59
  v_and_or_b32 v19, v19, s60, v18
  v_and_or_b32 v23, v17, s61, v19
  buffer_store_dword v23, v13, s[36:39], s63 offen offset:1536 nt
  v_mul_f32 v16, s58, v68
  v_mul_f32 v17, s58, v84
  v_cvt_pk_bf16_f32 v18, v16, v16
  v_and_b32 v19, 0x7fffffff, v17
  v_and_b32 v18, 0xffff, v18
  v_add_u32 v19, 0x8000, v19
  v_sub_u32 v19, v19, v18
  v_med3_i32 v19, v19, 0, s59
  v_and_or_b32 v19, v19, s60, v18
  v_and_or_b32 v20, v17, s61, v19
  s_add_u32 s63, s62, 4096
  buffer_store_dword v20, v13, s[36:39], s63 offen offset:0 nt
  v_mul_f32 v16, s58, v69
  v_mul_f32 v17, s58, v85
  v_cvt_pk_bf16_f32 v18, v16, v16
  v_and_b32 v19, 0x7fffffff, v17
  v_and_b32 v18, 0xffff, v18
  v_add_u32 v19, 0x8000, v19
  v_sub_u32 v19, v19, v18
  v_med3_i32 v19, v19, 0, s59
  v_and_or_b32 v19, v19, s60, v18
  v_and_or_b32 v21, v17, s61, v19
  buffer_store_dword v21, v13, s[36:39], s63 offen offset:512 nt
  v_mul_f32 v16, s58, v70
  v_mul_f32 v17, s58, v86
  v_cvt_pk_bf16_f32 v18, v16, v16
  v_and_b32 v19, 0x7fffffff, v17
  v_and_b32 v18, 0xffff, v18
  v_add_u32 v19, 0x8000, v19
  v_sub_u32 v19, v19, v18
  v_med3_i32 v19, v19, 0, s59
  v_and_or_b32 v19, v19, s60, v18
  v_and_or_b32 v22, v17, s61, v19
  buffer_store_dword v22, v13, s[36:39], s63 offen offset:1024 nt
  v_mul_f32 v16, s58, v71
  v_mul_f32 v17, s58, v87
  v_cvt_pk_bf16_f32 v18, v16, v16
  v_and_b32 v19, 0x7fffffff, v17
  v_and_b32 v18, 0xffff, v18
  v_add_u32 v19, 0x8000, v19
  v_sub_u32 v19, v19, v18
  v_med3_i32 v19, v19, 0, s59
  v_and_or_b32 v19, v19, s60, v18
  v_and_or_b32 v23, v17, s61, v19
  buffer_store_dword v23, v13, s[36:39], s63 offen offset:1536 nt
  v_mul_f32 v16, s58, v72
  v_mul_f32 v17, s58, v88
  v_cvt_pk_bf16_f32 v18, v16, v16
  v_and_b32 v19, 0x7fffffff, v17
  v_and_b32 v18, 0xffff, v18
  v_add_u32 v19, 0x8000, v19
  v_sub_u32 v19, v19, v18
  v_med3_i32 v19, v19, 0, s59
  v_and_or_b32 v19, v19, s60, v18
  v_and_or_b32 v20, v17, s61, v19
  s_add_u32 s63, s62, 8192
  buffer_store_dword v20, v13, s[36:39], s63 offen offset:0 nt
  v_mul_f32 v16, s58, v73
  v_mul_f32 v17, s58, v89
  v_cvt_pk_bf16_f32 v18, v16, v16
  v_and_b32 v19, 0x7fffffff, v17
  v_and_b32 v18, 0xffff, v18
  v_add_u32 v19, 0x8000, v19
  v_sub_u32 v19, v19, v18
  v_med3_i32 v19, v19, 0, s59
  v_and_or_b32 v19, v19, s60, v18
  v_and_or_b32 v21, v17, s61, v19
  buffer_store_dword v21, v13, s[36:39], s63 offen offset:512 nt
  v_mul_f32 v16, s58, v74
  v_mul_f32 v17, s58, v90
  v_cvt_pk_bf16_f32 v18, v16, v16
  v_and_b32 v19, 0x7fffffff, v17
  v_and_b32 v18, 0xffff, v18
  v_add_u32 v19, 0x8000, v19
  v_sub_u32 v19, v19, v18
  v_med3_i32 v19, v19, 0, s59
  v_and_or_b32 v19, v19, s60, v18
  v_and_or_b32 v22, v17, s61, v19
  buffer_store_dword v22, v13, s[36:39], s63 offen offset:1024 nt
  v_mul_f32 v16, s58, v75
  v_mul_f32 v17, s58, v91
  v_cvt_pk_bf16_f32 v18, v16, v16
  v_and_b32 v19, 0x7fffffff, v17
  v_and_b32 v18, 0xffff, v18
  v_add_u32 v19, 0x8000, v19
  v_sub_u32 v19, v19, v18
  v_med3_i32 v19, v19, 0, s59
  v_and_or_b32 v19, v19, s60, v18
  v_and_or_b32 v23, v17, s61, v19
  buffer_store_dword v23, v13, s[36:39], s63 offen offset:1536 nt
  v_mul_f32 v16, s58, v76
  v_mul_f32 v17, s58, v92
  v_cvt_pk_bf16_f32 v18, v16, v16
  v_and_b32 v19, 0x7fffffff, v17
  v_and_b32 v18, 0xffff, v18
  v_add_u32 v19, 0x8000, v19
  v_sub_u32 v19, v19, v18
  v_med3_i32 v19, v19, 0, s59
  v_and_or_b32 v19, v19, s60, v18
  v_and_or_b32 v20, v17, s61, v19
  s_add_u32 s63, s62, 12288
  buffer_store_dword v20, v13, s[36:39], s63 offen offset:0 nt
  v_mul_f32 v16, s58, v77
  v_mul_f32 v17, s58, v93
  v_cvt_pk_bf16_f32 v18, v16, v16
  v_and_b32 v19, 0x7fffffff, v17
  v_and_b32 v18, 0xffff, v18
  v_add_u32 v19, 0x8000, v19
  v_sub_u32 v19, v19, v18
  v_med3_i32 v19, v19, 0, s59
  v_and_or_b32 v19, v19, s60, v18
  v_and_or_b32 v21, v17, s61, v19
  buffer_store_dword v21, v13, s[36:39], s63 offen offset:512 nt
  v_mul_f32 v16, s58, v78
  v_mul_f32 v17, s58, v94
  v_cvt_pk_bf16_f32 v18, v16, v16
  v_and_b32 v19, 0x7fffffff, v17
  v_and_b32 v18, 0xffff, v18
  v_add_u32 v19, 0x8000, v19
  v_sub_u32 v19, v19, v18
  v_med3_i32 v19, v19, 0, s59
  v_and_or_b32 v19, v19, s60, v18
  v_and_or_b32 v22, v17, s61, v19
  buffer_store_dword v22, v13, s[36:39], s63 offen offset:1024 nt
  v_mul_f32 v16, s58, v79
  v_mul_f32 v17, s58, v95
  v_cvt_pk_bf16_f32 v18, v16, v16
  v_and_b32 v19, 0x7fffffff, v17
  v_and_b32 v18, 0xffff, v18
  v_add_u32 v19, 0x8000, v19
  v_sub_u32 v19, v19, v18
  v_med3_i32 v19, v19, 0, s59
  v_and_or_b32 v19, v19, s60, v18
  v_and_or_b32 v23, v17, s61, v19
  buffer_store_dword v23, v13, s[36:39], s63 offen offset:1536 nt
  s_endpgm
K1_IMG:
  s_sub_u32 s26, s2, 222
  s_lshr_b32 s27, s26, 3
  s_and_b32 s28, s26, 7
  s_waitcnt lgkmcnt(0)
  s_mov_b32 s40, s24
  s_and_b32 s41, s25, 0xffff
  s_mov_b32 s42, 17178624
  s_mov_b32 s43, 0x00020000
  v_and_b32 v1, 63, v0
  v_bfe_u32 v2, v0, 6, 3
  v_and_b32 v3, 15, v1
  v_lshrrev_b32 v4, 4, v1
  s_cmp_eq_u32 s27, 3
  s_cbranch_scc1 K1I_W3
  s_cmp_eq_u32 s27, 0
  s_cbranch_scc1 K1I_W1
  s_mov_b32 s32, s18
  s_and_b32 s33, s19, 0xffff
  s_mov_b32 s34, 262144
  s_mov_b32 s35, 0x00020000
  s_cmp_eq_u32 s27, 1
  s_cbranch_scc1 K1I_WH1
  v_lshrrev_b32 v5, 1, v2
  v_lshlrev_b32 v5, 6, v5
  v_lshl_add_u32 v5, v4, 4, v5
  v_and_b32 v6, 1, v2
  v_add3_u32 v5, v5, v6, 0
  v_add_u32 v5, 256, v5
  s_movk_i32 s44, 1024
  s_mov_b32 s45, 3207688728
  s_mov_b32 s46, 17039360
  s_branch K1I_COLNAT
K1I_WH1:
  v_lshlrev_b32 v5, 5, v2
  v_lshl_add_u32 v5, v4, 3, v5
  s_movk_i32 s44, 512
  s_mov_b32 s45, 1.0
  s_mov_b32 s46, 16908288
K1I_COLNAT:
  s_lshl_b32 s47, s28, 5
  v_add_u32 v6, s47, v3
  v_lshlrev_b32 v6, 1, v6
  v_lshl_add_u32 v7, v5, 9, v6
  v_add_u32 v8, 32, v7
  s_branch K1I_GO
K1I_W1:
  s_mov_b32 s32, s14
  s_and_b32 s33, s15, 0xffff
  s_mov_b32 s34, 270848
  s_mov_b32 s35, 0x00020000
  v_lshlrev_b32 v5, 5, v2
  v_lshl_add_u32 v5, v4, 3, v5
  s_movk_i32 s44, 512
  s_mov_b32 s45, 1.0
  s_mov_b32 s46, 16777216
  s_lshr_b32 s47, s28, 1
  s_lshl_b32 s47, s47, 6
  s_and_b32 s48, s28, 1
  s_add_u32 s47, s47, s48
  v_lshl_add_u32 v6, v3, 1, s47
  v_lshlrev_b32 v6, 1, v6
  v_lshl_add_u32 v7, v5, 9, v6
  v_add_u32 v8, 64, v7
  s_branch K1I_GO
K1I_W3:
  s_mov_b32 s32, s14
  s_and_b32 s33, s15, 0xffff
  s_mov_b32 s34, 270848
  s_mov_b32 s35, 0x00020000
  v_and_b32 v3, 31, v1
  v_lshrrev_b32 v4, 5, v1
  v_lshlrev_b32 v5, 3, v4
  v_add_u32 v5, 513, v5
  v_lshrrev_b32 v6, 7, v0
  v_lshlrev_b32 v6, 6, v6
  v_lshl_add_u32 v6, v3, 1, v6
  v_bfe_u32 v9, v0, 6, 1
  v_add_u32 v6, v6, v9
  v_lshlrev_b32 v6, 1, v6
  v_lshl_add_u32 v7, v5, 9, v6
  v_mov_b32 v8, 0x7ffffff0
  s_movk_i32 s44, 512
  s_mov_b32 s45, 3216550459
  s_mov_b32 s46, 17170432
  s_mov_b32 s28, 0
K1I_GO:
  s_mov_b32 s47, 0
  buffer_load_ushort v16, v7, s[32:35], s47 offen
  buffer_load_ushort v24, v8, s[32:35], s47 offen
  s_add_u32 s47, s47, s44
  buffer_load_ushort v17, v7, s[32:35], s47 offen
  buffer_load_ushort v25, v8, s[32:35], s47 offen
  s_add_u32 s47, s47, s44
  buffer_load_ushort v18, v7, s[32:35], s47 offen
  buffer_load_ushort v26, v8, s[32:35], s47 offen
  s_add_u32 s47, s47, s44
  buffer_load_ushort v19, v7, s[32:35], s47 offen
  buffer_load_ushort v27, v8, s[32:35], s47 offen
  s_add_u32 s47, s47, s44
  buffer_load_ushort v20, v7, s[32:35], s47 offen
  buffer_load_ushort v28, v8, s[32:35], s47 offen
  s_add_u32 s47, s47, s44
  buffer_load_ushort v21, v7, s[32:35], s47 offen
  buffer_load_ushort v29, v8, s[32:35], s47 offen
  s_add_u32 s47, s47, s44
  buffer_load_ushort v22, v7, s[32:35], s47 offen
  buffer_load_ushort v30, v8, s[32:35], s47 offen
  s_add_u32 s47, s47, s44
  buffer_load_ushort v23, v7, s[32:35], s47 offen
  buffer_load_ushort v31, v8, s[32:35], s47 offen
  s_add_u32 s47, s47, s44
  s_lshl_b32 s48, s28, 14
  s_add_u32 s48, s48, s46
  v_lshlrev_b32 v10, 4, v0
  v_add_u32 v10, s48, v10
  v_add_u32 v11, 8192, v10
  s_cmp_eq_u32 s27, 3
  s_cselect_b32 s49, 0x7ffffff0, 0
  v_or_b32 v11, s49, v11
  s_waitcnt vmcnt(0)
  v_lshlrev_b32 v16, 16, v16
  v_mul_f32 v16, s45, v16
  v_lshlrev_b32 v17, 16, v17
  v_mul_f32 v17, s45, v17
  v_lshlrev_b32 v18, 16, v18
  v_mul_f32 v18, s45, v18
  v_lshlrev_b32 v19, 16, v19
  v_mul_f32 v19, s45, v19
  v_lshlrev_b32 v20, 16, v20
  v_mul_f32 v20, s45, v20
  v_lshlrev_b32 v21, 16, v21
  v_mul_f32 v21, s45, v21
  v_lshlrev_b32 v22, 16, v22
  v_mul_f32 v22, s45, v22
  v_lshlrev_b32 v23, 16, v23
  v_mul_f32 v23, s45, v23
  v_cvt_pk_bf16_f32 v32, v16, v17
  v_cvt_pk_bf16_f32 v33, v18, v19
  v_cvt_pk_bf16_f32 v34, v20, v21
  v_cvt_pk_bf16_f32 v35, v22, v23
  buffer_store_dwordx4 v[32:35], v10, s[40:43], 0 offen
  v_lshlrev_b32 v24, 16, v24
  v_mul_f32 v24, s45, v24
  v_lshlrev_b32 v25, 16, v25
  v_mul_f32 v25, s45, v25
  v_lshlrev_b32 v26, 16, v26
  v_mul_f32 v26, s45, v26
  v_lshlrev_b32 v27, 16, v27
  v_mul_f32 v27, s45, v27
  v_lshlrev_b32 v28, 16, v28
  v_mul_f32 v28, s45, v28
  v_lshlrev_b32 v29, 16, v29
  v_mul_f32 v29, s45, v29
  v_lshlrev_b32 v30, 16, v30
  v_mul_f32 v30, s45, v30
  v_lshlrev_b32 v31, 16, v31
  v_mul_f32 v31, s45, v31
  v_cvt_pk_bf16_f32 v36, v24, v25
  v_cvt_pk_bf16_f32 v37, v26, v27
  v_cvt_pk_bf16_f32 v38, v28, v29
  v_cvt_pk_bf16_f32 v39, v30, v31
  buffer_store_dwordx4 v[36:39], v11, s[40:43], 0 offen
K1_END:
  s_endpgm
.globl egnn_k2_kernel
.p2align 8
.type egnn_k2_kernel,@function
egnn_k2_kernel:
  s_cmp_ge_u32 s2, 250
  s_cbranch_scc1 K2_END
  s_load_dwordx2 s[24:25], s[0:1], 80
  s_load_dwordx16 s[4:19], s[0:1], 0
  s_load_dwordx4 s[20:23], s[0:1], 64
  v_mov_b32 v122, v0
  v_and_b32 v126, 63, v0
  v_lshrrev_b32 v120, 6, v0
  s_nop 0
  v_readfirstlane_b32 s52, v120
  s_lshl_b32 s87, s2, 15
  s_add_u32 s87, s87, 5242880
  s_add_u32 s88, s87, 16384
  s_and_b32 s53, s52, 3
  s_lshr_b32 s54, s52, 2
  v_and_b32 v6, 31, v126
  v_lshrrev_b32 v7, 5, v126
  v_lshlrev_b32 v123, 4, v126
  v_lshlrev_b32 v1, 4, v7
  s_lshl_b32 s55, s53, 7
  v_lshl_add_u32 v2, v6, 2, s55
  v_lshlrev_b32 v0, 10, v7
  v_lshl_add_u32 v0, v6, 4, v0
  v_add_u32 v0, 8704, v0
  v_bfe_u32 v121, v6, 2, 1
  v_lshlrev_b32 v4, 4, v121
  v_and_b32 v121, 3, v6
  v_add_u32 v4, v4, v121
  v_lshrrev_b32 v121, 3, v6
  v_lshl_add_u32 v4, v121, 2, v4
  v_lshlrev_b32 v4, 3, v4
  v_add_u32 v4, 149504, v4
  s_lshl_b32 s55, s2, 8
  s_add_u32 s55, s55, 13434880
  v_lshrrev_b32 v120, 4, v122
  v_lshlrev_b32 v120, 2, v120
  v_lshlrev_b32 v8, 2, v126
  v_add_u32 v8, 156160, v8
  v_mov_b32 v9, 0
  s_mov_b64 exec, 0xffff
  ds_write_b32 v8, v9
  s_mov_b64 exec, -1
  s_waitcnt lgkmcnt(0)
  s_barrier
  s_mov_b32 s40, s24
  s_and_b32 s41, s25, 0xffff
  s_mov_b32 s42, 17178624
  s_mov_b32 s43, 0x00020000
  s_mov_b32 s32, s8
  s_and_b32 s33, s9, 0xffff
  s_mov_b32 s34, 5120000
  s_mov_b32 s35, 0x00020000
  s_mov_b32 s36, s24
  s_and_b32 s37, s25, 0xffff
  s_mov_b32 s38, 5120000
  s_mov_b32 s39, 0x00020000
  s_mov_b32 s44, s20
  s_and_b32 s45, s21, 0xffff
  s_mov_b32 s46, 5180000
  s_mov_b32 s47, 0x00020000
  s_mov_b32 s80, 1
  s_mov_b64 s[82:83], 0
  s_mov_b32 s84, 0
  s_mov_b32 s85, 0
  s_mov_b32 s86, 0
  s_mov_b32 s81, 0
  s_cmp_ge_u32 s52, 8
  s_cbranch_scc1 K2_GW
  buffer_load_dword v116, v120, s[40:43], s55 offen
  buffer_load_dword v117, v120, s[40:43], s55 offen offset:128
  v_lshlrev_b32 v121, 4, v122
  v_add_u32 v120, 8192, v121
  buffer_load_dwordx4 v[100:103], v121, s[40:43], s87 offen
  buffer_load_dwordx4 v[104:107], v120, s[40:43], s87 offen
  s_mov_b32 s48, s14
  s_and_b32 s49, s15, 0xffff
  s_mov_b32 s50, 270848
  s_mov_b32 s51, 0x00020000
  s_mov_b32 s14, 0
  v_mov_b32 v24, 0
  v_mov_b32 v25, 0
  v_mov_b32 v26, 0
  v_mov_b32 v27, 0
  v_add_u32 v28, 8704, v121
  ds_write_b128 v28, v[24:27] offset:0
  ds_write_b128 v28, v[24:27] offset:8192
  ds_write_b128 v28, v[24:27] offset:16384
  ds_write_b128 v28, v[24:27] offset:24576
  ds_write_b128 v28, v[24:27] offset:32768
  ds_write_b128 v28, v[24:27] offset:40960
  ds_write_b128 v28, v[24:27] offset:49152
  v_add_u32 v28, 57344, v28
  ds_write_b128 v28, v[24:27] offset:0
  ds_write_b128 v28, v[24:27] offset:8192
  ds_write_b128 v28, v[24:27] offset:16384
  ds_write_b128 v28, v[24:27] offset:24576
  v_cmp_gt_u32 vcc, 400, v122
  s_nop 0
  s_and_saveexec_b64 s[70:71], vcc
  ds_write_b128 v28, v[24:27] offset:32768
  s_mov_b64 exec, s[70:71]
  s_waitcnt vmcnt(2)
  v_and_b32 v119, 15, v122
  v_cmp_lt_u32 s[76:77], v119, v116
  v_cmp_lt_u32 s[78:79], v119, v117
  v_add_u32 v119, 16, v119
  v_cmp_lt_u32 s[16:17], v119, v116
  v_cmp_lt_u32 s[18:19], v119, v117
  s_mov_b64 exec, s[16:17]
  s_cbranch_execz K2_NOA1
  buffer_load_dwordx4 v[108:111], v121, s[40:43], s88 offen
K2_NOA1:
  s_mov_b64 exec, s[18:19]
  s_cbranch_execz K2_NOB1
  buffer_load_dwordx4 v[112:115], v120, s[40:43], s88 offen
K2_NOB1:
  s_mov_b64 exec, -1
  v_mov_b32 v24, 5242880
  v_mov_b32 v25, 480
  v_mov_b32 v26, 5242880
  v_mov_b32 v27, 480
  v_add_u32 v28, 149504, v121
  v_cmp_gt_u32 vcc, 384, v122
  s_nop 0
  s_and_saveexec_b64 s[70:71], vcc
  ds_write_b128 v28, v[24:27]
  s_mov_b64 exec, s[70:71]
  v_mov_b32 v25, 5242880
  v_mov_b32 v27, 5242880
  v_add_u32 v28, 146432, v121
  v_cmp_gt_u32 vcc, 192, v122
  s_nop 0
  s_and_saveexec_b64 s[70:71], vcc
  ds_write_b128 v28, v[24:27]
  s_mov_b64 exec, s[70:71]
  v_lshrrev_b32 v92, 1, v122
  v_and_b32 v93, 1, v122
  v_lshlrev_b32 v93, 3, v93
  v_sub_u32 v92, v92, v93
  v_lshrrev_b32 v93, 1, v92
  v_and_b32 v94, 1, v92
  v_lshlrev_b32 v94, 4, v94
  v_mov_b32 v95, 0x3f80
  v_lshlrev_b32 v95, v94, v95
  v_cmp_eq_u32 vcc, 0, v93
  s_nop 1
  v_cndmask_b32 v24, 0, v95, vcc
  v_cmp_eq_u32 vcc, 1, v93
  s_nop 1
  v_cndmask_b32 v25, 0, v95, vcc
  v_cmp_eq_u32 vcc, 2, v93
  s_nop 1
  v_cndmask_b32 v26, 0, v95, vcc
  v_cmp_eq_u32 vcc, 3, v93
  s_nop 1
  v_cndmask_b32 v27, 0, v95, vcc
  v_cmp_eq_u32 vcc, 31, v122
  s_nop 1
  v_cndmask_b32 v27, v27, 0, vcc
  v_cmp_gt_u32 vcc, 32, v122
  s_nop 0
  s_and_saveexec_b64 s[70:71], vcc
  ds_write_b128 v121, v[24:27]
  s_mov_b64 exec, s[70:71]
  s_waitcnt lgkmcnt(0)
  v_mov_b32 v36, 156160
  v_mov_b32 v37, 1
  s_mov_b64 exec, 1
  ds_add_u32 v36, v37
  s_mov_b64 exec, -1
  v_mov_b32 v36, 156160
K2_SBW1:
  ds_read_b32 v37, v36
  s_waitcnt lgkmcnt(0)
  v_readfirstlane_b32 s69, v37
  s_nop 0
  s_cmp_ge_u32 s69, 8
  s_cbranch_scc1 K2_SBW1X
  s_sleep 1
  s_branch K2_SBW1
K2_SBW1X:
  s_waitcnt vmcnt(0)
  s_branch K2_B1
K2_GW:
  s_mov_b32 s28, s4
  s_and_b32 s29, s5, 0xffff
  s_mov_b32 s30, 5120000
  s_mov_b32 s31, 0x00020000
  s_mov_b32 s48, s14
  s_and_b32 s49, s15, 0xffff
  s_mov_b32 s50, 270848
  s_mov_b32 s51, 0x00020000
  s_sub_u32 s67, s52, 8
  s_mul_i32 s55, s67, 5
  s_mul_i32 s14, s2, 40
  s_add_u32 s68, s55, 0
  v_add_u32 v8, s68, v7
  v_and_b32 v9, 15, v8
  v_xor_b32 v9, v9, v6
  v_lshlrev_b32 v9, 4, v9
  v_lshl_or_b32 v9, v7, 9, v9
  s_add_u32 s56, s14, s68
  s_lshl_b32 s56, s56, 9
  s_lshl_b32 s57, s68, 9
  s_add_u32 m0, s57, 125952
  s_nop 0
  buffer_load_dwordx4 v9, s[28:31], s56 offen lds
  s_add_u32 s68, s55, 2
  v_add_u32 v8, s68, v7
  v_and_b32 v9, 15, v8
  v_xor_b32 v9, v9, v6
  v_lshlrev_b32 v9, 4, v9
  v_lshl_or_b32 v9, v7, 9, v9
  s_add_u32 s56, s14, s68
  s_lshl_b32 s56, s56, 9
  s_lshl_b32 s57, s68, 9
  s_add_u32 m0, s57, 125952
  s_nop 0
  buffer_load_dwordx4 v9, s[28:31], s56 offen lds
  s_add_u32 s68, s55, 4
  v_add_u32 v8, s68, v7
  v_and_b32 v9, 15, v8
  v_xor_b32 v9, v9, v6
  v_lshlrev_b32 v9, 4, v9
  v_lshl_or_b32 v9, v7, 9, v9
  s_add_u32 s56, s14, s68
  s_lshl_b32 s56, s56, 9
  s_lshl_b32 s57, s68, 9
  s_add_u32 m0, s57, 125952
  s_mov_b64 exec, 0xffffffff
  buffer_load_dwordx4 v9, s[28:31], s56 offen lds
  s_mov_b64 exec, -1
  s_lshl_b32 s56, s67, 10
  s_add_u32 m0, s56, 512
  s_add_u32 s56, s56, 17170432
  buffer_load_dwordx4 v123, s[40:43], s56 offen lds
  s_mov_b32 s72, s16
  s_and_b32 s73, s17, 0xffff
  s_mov_b32 s74, 512
  s_mov_b32 s75, 0x00020000
  v_subrev_u32 v120, 512, v122
  v_and_b32 v16, 0xc0, v120
  v_lshl_add_u32 v16, v6, 1, v16
  v_bfe_u32 v17, v120, 5, 1
  v_add_u32 v16, v16, v17
  v_lshlrev_b32 v16, 1, v16
  v_mov_b32 v18, 0x7ffffff0
  v_cmp_gt_u32 vcc, 256, v120
  s_nop 1
  v_cndmask_b32 v16, v18, v16, vcc
  buffer_load_ushort v124, v16, s[72:75], 0 offen
  v_lshrrev_b32 v19, 6, v120
  v_lshlrev_b32 v19, 7, v19
  v_lshl_add_u32 v19, v17, 6, v19
  v_lshrrev_b32 v18, 4, v6
  v_lshl_add_u32 v19, v18, 5, v19
  v_bfe_u32 v18, v6, 2, 1
  v_lshl_add_u32 v19, v18, 4, v19
  v_and_b32 v18, 3, v6
  v_lshl_add_u32 v19, v18, 1, v19
  v_bfe_u32 v18, v6, 3, 1
  v_lshl_add_u32 v19, v18, 3, v19
  v_add_u32 v125, 155648, v19
  s_mov_b32 s13, 262144
  buffer_load_dword v3, v2, s[48:51], s13 offen
  s_mov_b32 s14, 0
  s_lshl_b32 s13, s67, 14
  s_add_u32 s13, s13, 16777216
  s_add_u32 s12, s13, 8192
  buffer_load_dwordx4 v[56:59], v123, s[40:43], s13 offen offset:0
  buffer_load_dwordx4 v[88:91], v123, s[40:43], s12 offen offset:0
  buffer_load_dwordx4 v[60:63], v123, s[40:43], s13 offen offset:1024
  buffer_load_dwordx4 v[92:95], v123, s[40:43], s12 offen offset:1024
  buffer_load_dwordx4 v[64:67], v123, s[40:43], s13 offen offset:2048
  buffer_load_dwordx4 v[96:99], v123, s[40:43], s12 offen offset:2048
  buffer_load_dwordx4 v[68:71], v123, s[40:43], s13 offen offset:3072
  buffer_load_dwordx4 v[100:103], v123, s[40:43], s12 offen offset:3072
  s_add_u32 s13, s13, 4096
  s_add_u32 s12, s12, 4096
  buffer_load_dwordx4 v[72:75], v123, s[40:43], s13 offen offset:0
  buffer_load_dwordx4 v[104:107], v123, s[40:43], s12 offen offset:0
  buffer_load_dwordx4 v[76:79], v123, s[40:43], s13 offen offset:1024
  buffer_load_dwordx4 v[108:111], v123, s[40:43], s12 offen offset:1024
  buffer_load_dwordx4 v[80:83], v123, s[40:43], s13 offen offset:2048
  buffer_load_dwordx4 v[112:115], v123, s[40:43], s12 offen offset:2048
  buffer_load_dwordx4 v[84:87], v123, s[40:43], s13 offen offset:3072
  buffer_load_dwordx4 v[116:119], v123, s[40:43], s12 offen offset:3072
  s_waitcnt vmcnt(18)
  v_mov_b32 v8, 156164
  v_mov_b32 v9, 1
  s_mov_b64 exec, 1
  ds_add_u32 v8, v9
  s_mov_b64 exec, -1
  v_mov_b32 v8, 156164
K2_SBW2:
  ds_read_b32 v9, v8
  s_waitcnt lgkmcnt(0)
  v_readfirstlane_b32 s69, v9
  s_nop 0
  s_cmp_ge_u32 s69, 8
  s_cbranch_scc1 K2_SBW2X
  s_sleep 1
  s_branch K2_SBW2
K2_SBW2X:
  v_and_b32 v6, 15, v126
  v_lshrrev_b32 v7, 4, v126
  v_xor_b32 v120, v6, v7
  v_lshlrev_b32 v120, 4, v120
  v_lshl_add_u32 v120, v6, 9, v120
  v_add_u32 v120, 125952, v120
  v_xor_b32 v121, 0, v120
  ds_read_b128 v[32:35], v121 offset:0
  ds_read_b128 v[36:39], v121 offset:8192
  ds_read_b128 v[40:43], v121 offset:16384
  v_xor_b32 v121, 64, v120
  ds_read_b128 v[44:47], v121 offset:0
  ds_read_b128 v[48:51], v121 offset:8192
  ds_read_b128 v[52:55], v121 offset:16384
  s_waitcnt vmcnt(14) lgkmcnt(3)
  v_mfma_f32_16x16x32_bf16 v[8:11], v[32:35], v[56:59], 0
  v_mfma_f32_16x16x32_bf16 v[12:15], v[36:39], v[56:59], 0
  v_mfma_f32_16x16x32_bf16 v[16:19], v[40:43], v[56:59], 0
  v_mfma_f32_16x16x32_bf16 v[20:23], v[32:35], v[88:91], 0
  v_mfma_f32_16x16x32_bf16 v[24:27], v[36:39], v[88:91], 0
  v_mfma_f32_16x16x32_bf16 v[28:31], v[40:43], v[88:91], 0
  v_xor_b32 v121, 128, v120
  ds_read_b128 v[32:35], v121 offset:0
  ds_read_b128 v[36:39], v121 offset:8192
  ds_read_b128 v[40:43], v121 offset:16384
  s_waitcnt vmcnt(12) lgkmcnt(3)
  v_mfma_f32_16x16x32_bf16 v[8:11], v[44:47], v[60:63], v[8:11]
  v_mfma_f32_16x16x32_bf16 v[12:15], v[48:51], v[60:63], v[12:15]
  v_mfma_f32_16x16x32_bf16 v[16:19], v[52:55], v[60:63], v[16:19]
  v_mfma_f32_16x16x32_bf16 v[20:23], v[44:47], v[92:95], v[20:23]
  v_mfma_f32_16x16x32_bf16 v[24:27], v[48:51], v[92:95], v[24:27]
  v_mfma_f32_16x16x32_bf16 v[28:31], v[52:55], v[92:95], v[28:31]
  v_xor_b32 v121, 192, v120
  ds_read_b128 v[44:47], v121 offset:0
  ds_read_b128 v[48:51], v121 offset:8192
  ds_read_b128 v[52:55], v121 offset:16384
  s_waitcnt vmcnt(10) lgkmcnt(3)
  v_mfma_f32_16x16x32_bf16 v[8:11], v[32:35], v[64:67], v[8:11]
  v_mfma_f32_16x16x32_bf16 v[12:15], v[36:39], v[64:67], v[12:15]
  v_mfma_f32_16x16x32_bf16 v[16:19], v[40:43], v[64:67], v[16:19]
  v_mfma_f32_16x16x32_bf16 v[20:23], v[32:35], v[96:99], v[20:23]
  v_mfma_f32_16x16x32_bf16 v[24:27], v[36:39], v[96:99], v[24:27]
  v_mfma_f32_16x16x32_bf16 v[28:31], v[40:43], v[96:99], v[28:31]
  v_xor_b32 v121, 256, v120
  ds_read_b128 v[32:35], v121 offset:0
  ds_read_b128 v[36:39], v121 offset:8192
  ds_read_b128 v[40:43], v121 offset:16384
  s_waitcnt vmcnt(8) lgkmcnt(3)
  v_mfma_f32_16x16x32_bf16 v[8:11], v[44:47], v[68:71], v[8:11]
  v_mfma_f32_16x16x32_bf16 v[12:15], v[48:51], v[68:71], v[12:15]
  v_mfma_f32_16x16x32_bf16 v[16:19], v[52:55], v[68:71], v[16:19]
  v_mfma_f32_16x16x32_bf16 v[20:23], v[44:47], v[100:103], v[20:23]
  v_mfma_f32_16x16x32_bf16 v[24:27], v[48:51], v[100:103], v[24:27]
  v_mfma_f32_16x16x32_bf16 v[28:31], v[52:55], v[100:103], v[28:31]
  v_xor_b32 v121, 320, v120
  ds_read_b128 v[44:47], v121 offset:0
  ds_read_b128 v[48:51], v121 offset:8192
  ds_read_b128 v[52:55], v121 offset:16384
  s_waitcnt vmcnt(6) lgkmcnt(3)
  v_mfma_f32_16x16x32_bf16 v[8:11], v[32:35], v[72:75], v[8:11]
  v_mfma_f32_16x16x32_bf16 v[12:15], v[36:39], v[72:75], v[12:15]
  v_mfma_f32_16x16x32_bf16 v[16:19], v[40:43], v[72:75], v[16:19]
  v_mfma_f32_16x16x32_bf16 v[20:23], v[32:35], v[104:107], v[20:23]
  v_mfma_f32_16x16x32_bf16 v[24:27], v[36:39], v[104:107], v[24:27]
  v_mfma_f32_16x16x32_bf16 v[28:31], v[40:43], v[104:107], v[28:31]
  v_xor_b32 v121, 384, v120
  ds_read_b128 v[32:35], v121 offset:0
  ds_read_b128 v[36:39], v121 offset:8192
  ds_read_b128 v[40:43], v121 offset:16384
  s_waitcnt vmcnt(4) lgkmcnt(3)
  v_mfma_f32_16x16x32_bf16 v[8:11], v[44:47], v[76:79], v[8:11]
  v_mfma_f32_16x16x32_bf16 v[12:15], v[48:51], v[76:79], v[12:15]
  v_mfma_f32_16x16x32_bf16 v[16:19], v[52:55], v[76:79], v[16:19]
  v_mfma_f32_16x16x32_bf16 v[20:23], v[44:47], v[108:111], v[20:23]
  v_mfma_f32_16x16x32_bf16 v[24:27], v[48:51], v[108:111], v[24:27]
  v_mfma_f32_16x16x32_bf16 v[28:31], v[52:55], v[108:111], v[28:31]
  v_xor_b32 v121, 448, v120
  ds_read_b128 v[44:47], v121 offset:0
  ds_read_b128 v[48:51], v121 offset:8192
  ds_read_b128 v[52:55], v121 offset:16384
  s_waitcnt vmcnt(2) lgkmcnt(3)
  v_mfma_f32_16x16x32_bf16 v[8:11], v[32:35], v[80:83], v[8:11]
  v_mfma_f32_16x16x32_bf16 v[12:15], v[36:39], v[80:83], v[12:15]
  v_mfma_f32_16x16x32_bf16 v[16:19], v[40:43], v[80:83], v[16:19]
  v_mfma_f32_16x16x32_bf16 v[20:23], v[32:35], v[112:115], v[20:23]
  v_mfma_f32_16x16x32_bf16 v[24:27], v[36:39], v[112:115], v[24:27]
  v_mfma_f32_16x16x32_bf16 v[28:31], v[40:43], v[112:115], v[28:31]
  s_waitcnt vmcnt(0) lgkmcnt(0)
  v_mfma_f32_16x16x32_bf16 v[8:11], v[44:47], v[84:87], v[8:11]
  v_mfma_f32_16x16x32_bf16 v[12:15], v[48:51], v[84:87], v[12:15]
  v_mfma_f32_16x16x32_bf16 v[16:19], v[52:55], v[84:87], v[16:19]
  v_mfma_f32_16x16x32_bf16 v[20:23], v[44:47], v[116:119], v[20:23]
  v_mfma_f32_16x16x32_bf16 v[24:27], v[48:51], v[116:119], v[24:27]
  v_mfma_f32_16x16x32_bf16 v[28:31], v[52:55], v[116:119], v[28:31]
  s_sub_u32 s67, s52, 8
  s_lshl_b32 s55, s67, 5
  v_add_u32 v121, s55, v6
  v_mul_u32_u24 v121, 80, v121
  v_lshl_add_u32 v121, v7, 3, v121
  v_add_u32 v121, 105472, v121
  s_mov_b32 s55, 3216550459
  v_mul_f32 v8, s55, v8
  v_mul_f32 v9, s55, v9
  v_mul_f32 v10, s55, v10
  v_mul_f32 v11, s55, v11
  v_cvt_pk_bf16_f32 v32, v8, v9
  v_cvt_pk_bf16_f32 v33, v10, v11
  ds_write_b64 v121, v[32:33] offset:0
  v_mul_f32 v12, s55, v12
  v_mul_f32 v13, s55, v13
  v_mul_f32 v14, s55, v14
  v_mul_f32 v15, s55, v15
  v_cvt_pk_bf16_f32 v34, v12, v13
  v_cvt_pk_bf16_f32 v35, v14, v15
  ds_write_b64 v121, v[34:35] offset:32
  v_mul_f32 v16, s55, v16
  v_mul_f32 v17, s55, v17
  v_mul_f32 v18, s55, v18
  v_mul_f32 v19, s55, v19
  v_cvt_pk_bf16_f32 v36, v16, v17
  v_cvt_pk_bf16_f32 v37, v18, v19
  s_mov_b64 exec, 0xffffffff
  ds_write_b64 v121, v[36:37] offset:64
  s_mov_b64 exec, -1
  v_mul_f32 v20, s55, v20
  v_mul_f32 v21, s55, v21
  v_mul_f32 v22, s55, v22
  v_mul_f32 v23, s55, v23
  v_cvt_pk_bf16_f32 v38, v20, v21
  v_cvt_pk_bf16_f32 v39, v22, v23
  ds_write_b64 v121, v[38:39] offset:1280
  v_mul_f32 v24, s55, v24
  v_mul_f32 v25, s55, v25
  v_mul_f32 v26, s55, v26
  v_mul_f32 v27, s55, v27
  v_cvt_pk_bf16_f32 v40, v24, v25
  v_cvt_pk_bf16_f32 v41, v26, v27
  ds_write_b64 v121, v[40:41] offset:1312
  v_mul_f32 v28, s55, v28
  v_mul_f32 v29, s55, v29
  v_mul_f32 v30, s55, v30
  v_mul_f32 v31, s55, v31
  v_cvt_pk_bf16_f32 v42, v28, v29
  v_cvt_pk_bf16_f32 v43, v30, v31
  s_mov_b64 exec, 0xffffffff
  ds_write_b64 v121, v[42:43] offset:1344
  s_mov_b64 exec, -1
  s_waitcnt vmcnt(0)
  v_subrev_u32 v120, 512, v122
  v_cmp_gt_u32 vcc, 256, v120
  s_nop 0
  s_and_saveexec_b64 s[70:71], vcc
  ds_write_b16 v125, v124
  s_mov_b64 exec, s[70:71]
  v_mov_b32 v36, 156168
K2_SBW3:
  ds_read_b32 v37, v36
  s_waitcnt lgkmcnt(0)
  v_readfirstlane_b32 s69, v37
  s_nop 0
  s_cmp_ge_u32 s69, 8
  s_cbranch_scc1 K2_SBW3X
  s_sleep 1
  s_branch K2_SBW3
K2_SBW3X:
  s_branch K2_SCAN
K2_B1:
  v_max_u32 v118, v116, v117
  v_cmp_lt_u32 vcc, 32, v118
  s_nop 0
  s_and_saveexec_b64 s[70:71], vcc
  s_cbranch_execz K2_NOOV2
  v_lshrrev_b32 v119, 4, v122
  v_cmp_lt_u32 vcc, 32, v116
  s_nop 1
  v_cndmask_b32 v120, 0, 1, vcc
  v_mov_b32 v121, 0
  v_lshlrev_b64 v[120:121], v119, v[120:121]
  v_mov_b32 v119, 105208
  ds_or_b64 v119, v[120:121]
  v_lshrrev_b32 v119, 4, v122
  v_add_u32 v119, 32, v119
  v_cmp_lt_u32 vcc, 32, v117
  s_nop 1
  v_cndmask_b32 v120, 0, 1, vcc
  v_mov_b32 v121, 0
  v_lshlrev_b64 v[120:121], v119, v[120:121]
  v_mov_b32 v119, 105208
  ds_or_b64 v119, v[120:121]
K2_NOOV2:
  s_mov_b64 exec, s[70:71]
K2_BATCH:
  s_cmp_ge_u32 s52, 8
  s_cbranch_scc1 K2_RANKED
  v_mov_b32 v119, 1
  v_bfe_u32 v60, v100, 24, 6
  v_lshlrev_b32 v64, 2, v60
  v_add_u32 v118, 104960, v64
  s_mov_b64 exec, s[76:77]
  ds_add_rtn_u32 v68, v118, v119
  s_mov_b64 exec, -1
  v_bfe_u32 v61, v104, 24, 6
  v_lshlrev_b32 v65, 2, v61
  v_add_u32 v118, 104960, v65
  s_mov_b64 exec, s[78:79]
  ds_add_rtn_u32 v69, v118, v119
  s_mov_b64 exec, -1
  v_bfe_u32 v62, v108, 24, 6
  v_lshlrev_b32 v66, 2, v62
  v_add_u32 v118, 104960, v66
  s_mov_b64 exec, s[16:17]
  ds_add_rtn_u32 v70, v118, v119
  s_mov_b64 exec, -1
  v_bfe_u32 v63, v112, 24, 6
  v_lshlrev_b32 v67, 2, v63
  v_add_u32 v118, 104960, v67
  s_mov_b64 exec, s[18:19]
  ds_add_rtn_u32 v71, v118, v119
  s_mov_b64 exec, -1
  s_cmp_eq_u32 s80, 0
  s_cbranch_scc1 K2_RANKED
  s_mov_b32 s13, 262144
  buffer_load_dword v3, v2, s[48:51], s13 offen
  s_waitcnt lgkmcnt(0)
  v_mov_b32 v36, 156168
  v_mov_b32 v37, 1
  s_mov_b64 exec, 1
  ds_add_u32 v36, v37
  s_mov_b64 exec, -1
  v_mov_b32 v36, 156168
K2_SBW4:
  ds_read_b32 v37, v36
  s_waitcnt lgkmcnt(0)
  v_readfirstlane_b32 s69, v37
  s_nop 0
  s_cmp_ge_u32 s69, 8
  s_cbranch_scc1 K2_SBW4X
  s_sleep 1
  s_branch K2_SBW4
K2_SBW4X:
  s_branch K2_SCAN
K2_RANKED:
  s_waitcnt lgkmcnt(0)
  s_barrier
K2_SCAN:
  v_lshlrev_b32 v36, 2, v126
  v_add_u32 v36, 104960, v36
  ds_read_b32 v37, v36
  v_mov_b32 v38, 105208
  ds_read_b64 v[38:39], v38
  v_cmp_gt_u32 vcc, 40, v126
  s_waitcnt lgkmcnt(0)
  s_nop 0
  v_cndmask_b32 v37, 0, v37, vcc
  v_mov_b32 v40, v37
  s_nop 1
  v_add_u32_dpp v40, v40, v40 row_shr:1 row_mask:0xf bank_mask:0xf bound_ctrl:0
  s_nop 1
  v_add_u32_dpp v40, v40, v40 row_shr:2 row_mask:0xf bank_mask:0xf bound_ctrl:0
  s_nop 1
  v_add_u32_dpp v40, v40, v40 row_shr:4 row_mask:0xf bank_mask:0xf bound_ctrl:0
  s_nop 1
  v_add_u32_dpp v40, v40, v40 row_shr:8 row_mask:0xf bank_mask:0xf bound_ctrl:0
  s_nop 1
  v_add_u32_dpp v40, v40, v40 row_bcast:15 row_mask:0xa bank_mask:0xf
  s_nop 1
  v_add_u32_dpp v40, v40, v40 row_bcast:31 row_mask:0xc bank_mask:0xf
  v_sub_u32 v41, v40, v37
  s_cmp_eq_u32 s80, 0
  s_cbranch_scc1 K2_NOMASK
  v_readfirstlane_b32 s82, v38
  v_readfirstlane_b32 s83, v39
K2_NOMASK:
  v_readlane_b32 s56, v41, 8
  v_readlane_b32 s57, v41, 16
  v_readlane_b32 s58, v41, 24
  v_readlane_b32 s59, v41, 32
  v_readlane_b32 s60, v40, 39
  v_and_b32 v42, -32, v41
  v_cmp_le_u32 vcc, s56, v42
  s_nop 1
  v_cndmask_b32 v43, 0, 1, vcc
  v_cmp_le_u32 vcc, s57, v42
  s_nop 1
  v_addc_co_u32 v43, vcc, 0, v43, vcc
  v_cmp_le_u32 vcc, s58, v42
  s_nop 1
  v_addc_co_u32 v43, vcc, 0, v43, vcc
  v_cmp_le_u32 vcc, s59, v42
  s_nop 1
  v_addc_co_u32 v43, vcc, 0, v43, vcc
  v_lshlrev_b32 v43, 3, v43
  v_sub_u32 v43, v126, v43
  v_cmp_lt_i32 vcc, 14, v43
  v_cmp_lt_u32 s[70:71], 0, v37
  s_nop 0
  s_and_b64 vcc, vcc, s[70:71]
  s_cbranch_vccz K2_DENSE
  s_add_u32 s97, s56, 31
  s_and_b32 s97, s97, -32
  s_sub_u32 s98, s57, s56
  s_add_u32 s98, s98, 31
  s_and_b32 s98, s98, -32
  s_add_u32 s98, s98, s97
  s_sub_u32 s99, s58, s57
  s_add_u32 s99, s99, 31
  s_and_b32 s99, s99, -32
  s_add_u32 s99, s99, s98
  s_sub_u32 s100, s59, s58
  s_add_u32 s100, s100, 31
  s_and_b32 s100, s100, -32
  s_add_u32 s100, s100, s99
  s_sub_u32 s60, s60, s59
  s_add_u32 s60, s60, s100
  s_sub_u32 s69, s97, s56
  v_mov_b32 v42, s69
  v_cmp_le_u32 vcc, 8, v126
  s_nop 1
  v_cndmask_b32 v43, 0, v42, vcc
  s_sub_u32 s69, s98, s57
  v_mov_b32 v42, s69
  v_cmp_le_u32 vcc, 16, v126
  s_nop 1
  v_cndmask_b32 v43, v43, v42, vcc
  s_sub_u32 s69, s99, s58
  v_mov_b32 v42, s69
  v_cmp_le_u32 vcc, 24, v126
  s_nop 1
  v_cndmask_b32 v43, v43, v42, vcc
  s_sub_u32 s69, s100, s59
  v_mov_b32 v42, s69
  v_cmp_le_u32 vcc, 32, v126
  s_nop 1
  v_cndmask_b32 v43, v43, v42, vcc
  v_add_u32 v41, v41, v43
  v_and_b32 v43, 7, v126
  s_mov_b32 s56, s97
  s_mov_b32 s57, s98
  s_mov_b32 s58, s99
  s_mov_b32 s59, s100
K2_DENSE:
  s_add_u32 s61, s60, 31
  s_lshr_b32 s61, s61, 5
  s_mov_b32 s66, 0
  s_cmp_ge_u32 s52, 8
  s_cbranch_scc1 K2_GW2
  v_and_b32 v43, 15, v43
  v_lshl_or_b32 v41, v43, 16, v41
  ds_bpermute_b32 v24, v64, v41
  ds_bpermute_b32 v25, v65, v41
  ds_bpermute_b32 v26, v66, v41
  ds_bpermute_b32 v27, v67, v41
  s_waitcnt lgkmcnt(0)
  v_and_b32 v36, 0xffff, v24
  v_add_u32 v68, v36, v68
  v_xor_b32 v36, v36, v68
  v_lshrrev_b32 v72, 16, v24
  v_and_b32 v37, 7, v60
  v_cmp_gt_u32 vcc, 32, v36
  s_nop 1
  v_cndmask_b32 v72, v37, v72, vcc
  v_and_b32 v68, 0xfff, v68
  v_and_b32 v36, 0xffff, v25
  v_add_u32 v69, v36, v69
  v_xor_b32 v36, v36, v69
  v_lshrrev_b32 v73, 16, v25
  v_and_b32 v37, 7, v61
  v_cmp_gt_u32 vcc, 32, v36
  s_nop 1
  v_cndmask_b32 v73, v37, v73, vcc
  v_and_b32 v69, 0xfff, v69
  v_and_b32 v36, 0xffff, v26
  v_add_u32 v70, v36, v70
  v_xor_b32 v36, v36, v70
  v_lshrrev_b32 v74, 16, v26
  v_and_b32 v37, 7, v62
  v_cmp_gt_u32 vcc, 32, v36
  s_nop 1
  v_cndmask_b32 v74, v37, v74, vcc
  v_and_b32 v70, 0xfff, v70
  v_and_b32 v36, 0xffff, v27
  v_add_u32 v71, v36, v71
  v_xor_b32 v36, v36, v71
  v_lshrrev_b32 v75, 16, v27
  v_and_b32 v37, 7, v63
  v_cmp_gt_u32 vcc, 32, v36
  s_nop 1
  v_cndmask_b32 v75, v37, v75, vcc
  v_and_b32 v71, 0xfff, v71
  v_lshl_or_b32 v124, v72, 12, v68
  v_lshl_or_b32 v36, v73, 12, v69
  v_lshl_or_b32 v124, v36, 16, v124
  v_lshl_or_b32 v125, v74, 12, v70
  v_lshl_or_b32 v36, v75, 12, v71
  v_lshl_or_b32 v125, v36, 16, v125
  s_cmp_lg_u32 s80, 0
  s_cbranch_scc1 K2_CLEAN
  s_branch K2_ROUND
K2_GW2:
  s_cmp_eq_u32 s80, 0
  s_cbranch_scc1 K2_ROUND
  s_branch K2_WDONE
K2_ROUND:
  v_mbcnt_lo_u32_b32 v126, -1, 0
  v_mbcnt_hi_u32_b32 v126, -1, v126
  s_lshl_b32 s55, s52, 6
  v_add_u32 v122, s55, v126
  s_cmp_ge_u32 s52, 8
  s_cbranch_scc1 K2_RND2
  v_lshlrev_b32 v121, 4, v122
  v_add_u32 v120, 8192, v121
  buffer_load_dwordx4 v[100:103], v121, s[40:43], s87 offen
  buffer_load_dwordx4 v[104:107], v120, s[40:43], s87 offen
  buffer_load_dwordx4 v[108:111], v121, s[40:43], s88 offen
  buffer_load_dwordx4 v[112:115], v120, s[40:43], s88 offen
  v_mov_b32 v24, 0
  v_mov_b32 v25, 0
  v_mov_b32 v26, 0
  v_mov_b32 v27, 0
  v_add_u32 v28, 8704, v121
  ds_write_b128 v28, v[24:27] offset:0
  ds_write_b128 v28, v[24:27] offset:8192
  ds_write_b128 v28, v[24:27] offset:16384
  ds_write_b128 v28, v[24:27] offset:24576
  ds_write_b128 v28, v[24:27] offset:32768
  ds_write_b128 v28, v[24:27] offset:40960
  ds_write_b128 v28, v[24:27] offset:49152
  v_mov_b32 v24, 5242880
  v_mov_b32 v25, 480
  v_mov_b32 v26, 5242880
  v_mov_b32 v27, 480
  v_add_u32 v28, 149504, v121
  v_cmp_gt_u32 vcc, 384, v122
  s_nop 0
  s_and_saveexec_b64 s[70:71], vcc
  ds_write_b128 v28, v[24:27]
  s_mov_b64 exec, s[70:71]
  v_mov_b32 v25, 5242880
  v_mov_b32 v27, 5242880
  v_add_u32 v28, 146432, v121
  v_cmp_gt_u32 vcc, 192, v122
  s_nop 0
  s_and_saveexec_b64 s[70:71], vcc
  ds_write_b128 v28, v[24:27]
  s_mov_b64 exec, s[70:71]
  s_waitcnt vmcnt(0) lgkmcnt(0)
  v_bfe_u32 v60, v100, 24, 6
  v_bfe_u32 v68, v124, 0, 12
  v_bfe_u32 v72, v124, 12, 4
  v_bfe_u32 v61, v104, 24, 6
  v_bfe_u32 v69, v124, 16, 12
  v_bfe_u32 v73, v124, 28, 4
  v_bfe_u32 v62, v108, 24, 6
  v_bfe_u32 v70, v125, 0, 12
  v_bfe_u32 v74, v125, 12, 4
  v_bfe_u32 v63, v112, 24, 6
  v_bfe_u32 v71, v125, 16, 12
  v_bfe_u32 v75, v125, 28, 4
K2_RND2:
  s_barrier
  s_cmp_ge_u32 s52, 8
  s_cbranch_scc1 K2_WDONE
K2_CLEAN:
  s_mov_b32 s67, 0x7ffe00
  s_mov_b32 s68, 0xffff0000
  s_lshl_b32 s69, s66, 5
  v_subrev_u32 v24, s69, v68
  v_cmp_gt_u32 vcc, 768, v24
  s_nop 0
  s_and_b64 vcc, vcc, s[76:77]
  s_and_saveexec_b64 s[70:71], vcc
  s_cbranch_execz K2_WRA
  v_lshlrev_b32 v25, 2, v24
  v_and_b32 v26, s67, v100
  v_add_u32 v25, 146432, v25
  ds_write_b32 v25, v26
  v_lshlrev_b32 v26, 5, v72
  v_and_or_b32 v29, v103, s68, v26
  v_mov_b32 v28, v101
  v_lshlrev_b32 v25, 3, v24
  v_add_u32 v25, 149504, v25
  ds_write_b64 v25, v[28:29]
  v_lshrrev_b32 v25, 3, v24
  v_lshlrev_b32 v25, 9, v25
  v_and_b32 v26, 7, v24
  v_lshl_add_u32 v25, v26, 1, v25
  v_and_b32 v30, 7, v72
  v_lshl_add_u32 v25, v30, 6, v25
  v_lshrrev_b32 v32, 3, v60
  v_lshrrev_b32 v26, 5, v24
  v_sub_u32 v32, v32, v26
  v_add_u32 v32, 23, v32
  v_lshlrev_b32 v32, 11, v32
  v_cmp_lt_u32 vcc, 7, v72
  s_nop 1
  v_cndmask_b32 v32, 0, v32, vcc
  v_add_u32 v25, v25, v32
  v_mov_b32 v31, 0x3f80
  ds_write_b16 v25, v31 offset:8704
  ds_write_b16 v25, v102 offset:8720
  ds_write_b16_d16_hi v25, v102 offset:8736
  ds_write_b16 v25, v103 offset:8752
K2_WRA:
  s_mov_b64 exec, s[70:71]
  v_subrev_u32 v24, s69, v69
  v_cmp_gt_u32 vcc, 768, v24
  s_nop 0
  s_and_b64 vcc, vcc, s[78:79]
  s_and_saveexec_b64 s[70:71], vcc
  s_cbranch_execz K2_WRB
  v_lshlrev_b32 v25, 2, v24
  v_and_b32 v26, s67, v104
  v_add_u32 v25, 146432, v25
  ds_write_b32 v25, v26
  v_lshlrev_b32 v26, 5, v73
  v_and_or_b32 v29, v107, s68, v26
  v_mov_b32 v28, v105
  v_lshlrev_b32 v25, 3, v24
  v_add_u32 v25, 149504, v25
  ds_write_b64 v25, v[28:29]
  v_lshrrev_b32 v25, 3, v24
  v_lshlrev_b32 v25, 9, v25
  v_and_b32 v26, 7, v24
  v_lshl_add_u32 v25, v26, 1, v25
  v_and_b32 v30, 7, v73
  v_lshl_add_u32 v25, v30, 6, v25
  v_lshrrev_b32 v32, 3, v61
  v_lshrrev_b32 v26, 5, v24
  v_sub_u32 v32, v32, v26
  v_add_u32 v32, 23, v32
  v_lshlrev_b32 v32, 11, v32
  v_cmp_lt_u32 vcc, 7, v73
  s_nop 1
  v_cndmask_b32 v32, 0, v32, vcc
  v_add_u32 v25, v25, v32
  v_mov_b32 v31, 0x3f80
  ds_write_b16 v25, v31 offset:8704
  ds_write_b16 v25, v106 offset:8720
  ds_write_b16_d16_hi v25, v106 offset:8736
  ds_write_b16 v25, v107 offset:8752
K2_WRB:
  s_mov_b64 exec, s[70:71]
  v_subrev_u32 v24, s69, v70
  v_cmp_gt_u32 vcc, 768, v24
  s_nop 0
  s_and_b64 vcc, vcc, s[16:17]
  s_and_saveexec_b64 s[70:71], vcc
  s_cbranch_execz K2_WRC
  v_lshlrev_b32 v25, 2, v24
  v_and_b32 v26, s67, v108
  v_add_u32 v25, 146432, v25
  ds_write_b32 v25, v26
  v_lshlrev_b32 v26, 5, v74
  v_and_or_b32 v29, v111, s68, v26
  v_mov_b32 v28, v109
  v_lshlrev_b32 v25, 3, v24
  v_add_u32 v25, 149504, v25
  ds_write_b64 v25, v[28:29]
  v_lshrrev_b32 v25, 3, v24
  v_lshlrev_b32 v25, 9, v25
  v_and_b32 v26, 7, v24
  v_lshl_add_u32 v25, v26, 1, v25
  v_and_b32 v30, 7, v74
  v_lshl_add_u32 v25, v30, 6, v25
  v_lshrrev_b32 v32, 3, v62
  v_lshrrev_b32 v26, 5, v24
  v_sub_u32 v32, v32, v26
  v_add_u32 v32, 23, v32
  v_lshlrev_b32 v32, 11, v32
  v_cmp_lt_u32 vcc, 7, v74
  s_nop 1
  v_cndmask_b32 v32, 0, v32, vcc
  v_add_u32 v25, v25, v32
  v_mov_b32 v31, 0x3f80
  ds_write_b16 v25, v31 offset:8704
  ds_write_b16 v25, v110 offset:8720
  ds_write_b16_d16_hi v25, v110 offset:8736
  ds_write_b16 v25, v111 offset:8752
K2_WRC:
  s_mov_b64 exec, s[70:71]
  v_subrev_u32 v24, s69, v71
  v_cmp_gt_u32 vcc, 768, v24
  s_nop 0
  s_and_b64 vcc, vcc, s[18:19]
  s_and_saveexec_b64 s[70:71], vcc
  s_cbranch_execz K2_WRD
  v_lshlrev_b32 v25, 2, v24
  v_and_b32 v26, s67, v112
  v_add_u32 v25, 146432, v25
  ds_write_b32 v25, v26
  v_lshlrev_b32 v26, 5, v75
  v_and_or_b32 v29, v115, s68, v26
  v_mov_b32 v28, v113
  v_lshlrev_b32 v25, 3, v24
  v_add_u32 v25, 149504, v25
  ds_write_b64 v25, v[28:29]
  v_lshrrev_b32 v25, 3, v24
  v_lshlrev_b32 v25, 9, v25
  v_and_b32 v26, 7, v24
  v_lshl_add_u32 v25, v26, 1, v25
  v_and_b32 v30, 7, v75
  v_lshl_add_u32 v25, v30, 6, v25
  v_lshrrev_b32 v32, 3, v63
  v_lshrrev_b32 v26, 5, v24
  v_sub_u32 v32, v32, v26
  v_add_u32 v32, 23, v32
  v_lshlrev_b32 v32, 11, v32
  v_cmp_lt_u32 vcc, 7, v75
  s_nop 1
  v_cndmask_b32 v32, 0, v32, vcc
  v_add_u32 v25, v25, v32
  v_mov_b32 v31, 0x3f80
  ds_write_b16 v25, v31 offset:8704
  ds_write_b16 v25, v114 offset:8720
  ds_write_b16_d16_hi v25, v114 offset:8736
  ds_write_b16 v25, v115 offset:8752
K2_WRD:
  s_mov_b64 exec, s[70:71]
  s_cmp_eq_u32 s80, 0
  s_cbranch_scc1 K2_WDONE
  s_waitcnt lgkmcnt(0)
  v_mov_b32 v36, 156172
  v_mov_b32 v37, 1
  s_mov_b64 exec, 1
  ds_add_u32 v36, v37
  s_mov_b64 exec, -1
  v_mov_b32 v36, 156172
K2_SBW5:
  ds_read_b32 v37, v36
  s_waitcnt lgkmcnt(0)
  v_readfirstlane_b32 s69, v37
  s_nop 0
  s_cmp_ge_u32 s69, 8
  s_cbranch_scc1 K2_SBW5X
  s_sleep 1
  s_branch K2_SBW5
K2_SBW5X:
  s_sub_u32 s55, s61, s66
  s_min_u32 s55, s55, 24
  s_add_u32 s95, s55, 3
  s_lshr_b32 s95, s95, 2
  s_lshl_b32 s67, s95, 1
  s_min_u32 s67, s67, s55
  s_sub_u32 s68, s55, s67
  s_add_u32 s68, s68, 1
  s_lshr_b32 s4, s68, 1
  s_mul_i32 s62, s95, s54
  s_add_u32 s63, s62, s95
  s_cmp_lt_u32 s54, 2
  s_cbranch_scc1 K2_TR0
  s_mov_b32 s62, s67
  s_add_u32 s63, s67, s4
  s_cmp_eq_u32 s54, 2
  s_cbranch_scc1 K2_TR0
  s_mov_b32 s62, s63
  s_mov_b32 s63, s55
K2_TR0:
  s_min_u32 s63, s63, s55
  s_min_u32 s62, s62, s55
  s_add_u32 s55, s66, 24
  s_cmp_ge_u32 s55, s61
  s_cselect_b32 s81, 1, 0
  s_cmp_eq_u64 s[82:83], 0
  s_cselect_b32 s81, s81, 0
  s_lshl_b32 s55, s84, 11
  s_cmp_ge_u32 s55, s85
  s_cselect_b32 s81, s81, 0
  s_cmp_ge_u32 s62, s63
  s_cbranch_scc1 K2_WDONE
  s_waitcnt vmcnt(0)
  s_lshl_b32 s67, s62, 7
  s_add_u32 s68, s67, 146432
  v_lshl_add_u32 v6, v1, 2, s68
  ds_read_b128 v[44:47], v6 offset:0
  ds_read_b128 v[48:51], v6 offset:16
  ds_read_b128 v[52:55], v6 offset:32
  ds_read_b128 v[56:59], v6 offset:48
  s_lshl_b32 s68, s62, 8
  v_add_u32 v7, s68, v4
  ds_read_b64 v[6:7], v7
  s_waitcnt lgkmcnt(0)
  v_pk_add_f32 v[44:45], v[44:45], v[2:3] op_sel_hi:[1,0]
  v_pk_add_f32 v[46:47], v[46:47], v[2:3] op_sel_hi:[1,0]
  v_pk_add_f32 v[48:49], v[48:49], v[2:3] op_sel_hi:[1,0]
  v_pk_add_f32 v[50:51], v[50:51], v[2:3] op_sel_hi:[1,0]
  v_pk_add_f32 v[52:53], v[52:53], v[2:3] op_sel_hi:[1,0]
  v_pk_add_f32 v[54:55], v[54:55], v[2:3] op_sel_hi:[1,0]
  v_pk_add_f32 v[56:57], v[56:57], v[2:3] op_sel_hi:[1,0]
  v_pk_add_f32 v[58:59], v[58:59], v[2:3] op_sel_hi:[1,0]
  v_add_u32 v6, v6, v1
  v_mov_b32 v5, v7
  buffer_load_dwordx4 v[24:27], v6, s[32:35], 0 offen
  buffer_load_dword v44, v44, s[36:39], 0 offen
  buffer_load_dword v45, v45, s[36:39], 0 offen
  buffer_load_dword v46, v46, s[36:39], 0 offen
  buffer_load_dword v47, v47, s[36:39], 0 offen
  buffer_load_dword v48, v48, s[36:39], 0 offen
  buffer_load_dword v49, v49, s[36:39], 0 offen
  buffer_load_dword v50, v50, s[36:39], 0 offen
  buffer_load_dword v51, v51, s[36:39], 0 offen
  buffer_load_dword v52, v52, s[36:39], 0 offen
  buffer_load_dword v53, v53, s[36:39], 0 offen
  buffer_load_dword v54, v54, s[36:39], 0 offen
  buffer_load_dword v55, v55, s[36:39], 0 offen
  buffer_load_dword v56, v56, s[36:39], 0 offen
  buffer_load_dword v57, v57, s[36:39], 0 offen
  buffer_load_dword v58, v58, s[36:39], 0 offen
  buffer_load_dword v59, v59, s[36:39], 0 offen
  s_mov_b32 s14, 1
  s_mov_b32 s55, 3216550459
  v_lshlrev_b32 v36, 16, v3
  v_and_b32 v37, 0xffff0000, v3
  v_mul_f32 v36, s55, v36
  v_mul_f32 v37, s55, v37
  v_cvt_pk_bf16_f32 v3, v36, v37
  s_branch K2_NOWX
K2_WDONE:
  s_cmp_eq_u32 s80, 0
  s_cbranch_scc1 K2_NOWX
  s_waitcnt vmcnt(0)
  s_mov_b32 s55, 3216550459
  v_lshlrev_b32 v36, 16, v3
  v_and_b32 v37, 0xffff0000, v3
  v_mul_f32 v36, s55, v36
  v_mul_f32 v37, s55, v37
  v_cvt_pk_bf16_f32 v3, v36, v37
K2_NOWX:
  s_waitcnt lgkmcnt(0)
  s_barrier
  s_cmp_eq_u32 s80, 0
  s_cbranch_scc1 K2_NOW3
  s_lshl_b32 s55, s53, 11
  s_add_u32 s55, s55, 512
  v_add_u32 v36, s55, v123
  ds_read_b128 v[8:11], v36
  ds_read_b128 v[12:15], v36 offset:1024
K2_NOW3:
  s_sub_u32 s55, s61, s66
  s_min_u32 s55, s55, 24
  s_add_u32 s95, s55, 3
  s_lshr_b32 s95, s95, 2
  s_lshl_b32 s67, s95, 1
  s_min_u32 s67, s67, s55
  s_sub_u32 s68, s55, s67
  s_add_u32 s68, s68, 1
  s_lshr_b32 s4, s68, 1
  s_mul_i32 s62, s95, s54
  s_add_u32 s63, s62, s95
  s_cmp_lt_u32 s54, 2
  s_cbranch_scc1 K2_TR1
  s_mov_b32 s62, s67
  s_add_u32 s63, s67, s4
  s_cmp_eq_u32 s54, 2
  s_cbranch_scc1 K2_TR1
  s_mov_b32 s62, s63
  s_mov_b32 s63, s55
K2_TR1:
  s_min_u32 s63, s63, s55
  s_min_u32 s62, s62, s55
  s_add_u32 s55, s66, 24
  s_cmp_ge_u32 s55, s61
  s_cselect_b32 s81, 1, 0
  s_cmp_eq_u64 s[82:83], 0
  s_cselect_b32 s81, s81, 0
  s_lshl_b32 s55, s84, 11
  s_cmp_ge_u32 s55, s85
  s_cselect_b32 s81, s81, 0
  s_mov_b32 s64, -1
  s_mov_b32 s65, -1
  s_mov_b32 s89, -1
  s_mov_b32 s15, 0
  s_cmp_ge_u32 s62, s63
  s_cbranch_scc1 K2_LOOPEND
  s_mov_b32 s13, s62
  s_setprio 3
  s_cmp_eq_u32 s14, 1
  s_cbranch_scc1 K2_HAVE1
  s_lshl_b32 s67, s62, 7
  s_add_u32 s68, s67, 146432
  v_lshl_add_u32 v6, v1, 2, s68
  ds_read_b128 v[44:47], v6 offset:0
  ds_read_b128 v[48:51], v6 offset:16
  ds_read_b128 v[52:55], v6 offset:32
  ds_read_b128 v[56:59], v6 offset:48
  s_lshl_b32 s68, s62, 8
  v_add_u32 v7, s68, v4
  ds_read_b64 v[6:7], v7
  s_waitcnt lgkmcnt(0)
  v_pk_add_f32 v[44:45], v[44:45], v[2:3] op_sel_hi:[1,0]
  v_pk_add_f32 v[46:47], v[46:47], v[2:3] op_sel_hi:[1,0]
  v_pk_add_f32 v[48:49], v[48:49], v[2:3] op_sel_hi:[1,0]
  v_pk_add_f32 v[50:51], v[50:51], v[2:3] op_sel_hi:[1,0]
  v_pk_add_f32 v[52:53], v[52:53], v[2:3] op_sel_hi:[1,0]
  v_pk_add_f32 v[54:55], v[54:55], v[2:3] op_sel_hi:[1,0]
  v_pk_add_f32 v[56:57], v[56:57], v[2:3] op_sel_hi:[1,0]
  v_pk_add_f32 v[58:59], v[58:59], v[2:3] op_sel_hi:[1,0]
  v_add_u32 v6, v6, v1
  v_mov_b32 v5, v7
  buffer_load_dwordx4 v[24:27], v6, s[32:35], 0 offen
  buffer_load_dword v44, v44, s[36:39], 0 offen
  buffer_load_dword v45, v45, s[36:39], 0 offen
  buffer_load_dword v46, v46, s[36:39], 0 offen
  buffer_load_dword v47, v47, s[36:39], 0 offen
  buffer_load_dword v48, v48, s[36:39], 0 offen
  buffer_load_dword v49, v49, s[36:39], 0 offen
  buffer_load_dword v50, v50, s[36:39], 0 offen
  buffer_load_dword v51, v51, s[36:39], 0 offen
  buffer_load_dword v52, v52, s[36:39], 0 offen
  buffer_load_dword v53, v53, s[36:39], 0 offen
  buffer_load_dword v54, v54, s[36:39], 0 offen
  buffer_load_dword v55, v55, s[36:39], 0 offen
  buffer_load_dword v56, v56, s[36:39], 0 offen
  buffer_load_dword v57, v57, s[36:39], 0 offen
  buffer_load_dword v58, v58, s[36:39], 0 offen
  buffer_load_dword v59, v59, s[36:39], 0 offen
K2_HAVE1:
  s_mov_b32 s14, 0
  s_add_u32 s55, s62, s66
  s_lshl_b32 s55, s55, 5
  s_mov_b32 s67, 0
  s_mov_b32 s68, 0
  s_cmp_ge_u32 s55, s56
  s_cselect_b32 s68, s56, s68
  s_addc_u32 s67, s67, 0
  s_cmp_ge_u32 s55, s57
  s_cselect_b32 s68, s57, s68
  s_addc_u32 s67, s67, 0
  s_cmp_ge_u32 s55, s58
  s_cselect_b32 s68, s58, s68
  s_addc_u32 s67, s67, 0
  s_cmp_ge_u32 s55, s59
  s_cselect_b32 s68, s59, s68
  s_addc_u32 s67, s67, 0
  s_cmp_lt_u32 s68, s55
  s_cselect_b32 s89, s67, -1
  s_cmp_eq_u32 s54, 0
  s_cselect_b32 s89, -1, s89
K2_LOOP:
  s_sub_u32 s55, s63, s62
  s_cmp_ge_u32 s55, 4
  s_cbranch_scc1 K2_P3
  s_cmp_eq_u32 s55, 3
  s_cbranch_scc1 K2_P2
  s_cmp_eq_u32 s55, 2
  s_cbranch_scc1 K2_P1
  s_setprio 0
  s_branch K2_PD
K2_P1:
  s_setprio 1
  s_branch K2_PD
K2_P2:
  s_setprio 2
  s_branch K2_PD
K2_P3:
  s_setprio 3
K2_PD:
  s_add_u32 s55, s62, s66
  s_lshl_b32 s55, s55, 5
  s_mov_b32 s92, 0
  s_cmp_ge_u32 s55, s56
  s_addc_u32 s92, s92, 0
  s_cmp_ge_u32 s55, s57
  s_addc_u32 s92, s92, 0
  s_cmp_ge_u32 s55, s58
  s_addc_u32 s92, s92, 0
  s_cmp_ge_u32 s55, s59
  s_addc_u32 s92, s92, 0
  s_add_u32 s55, s55, 31
  s_sub_u32 s67, s60, 1
  s_min_u32 s55, s55, s67
  s_mov_b32 s93, 0
  s_cmp_ge_u32 s55, s56
  s_addc_u32 s93, s93, 0
  s_cmp_ge_u32 s55, s57
  s_addc_u32 s93, s93, 0
  s_cmp_ge_u32 s55, s58
  s_addc_u32 s93, s93, 0
  s_cmp_ge_u32 s55, s59
  s_addc_u32 s93, s93, 0
  s_sub_u32 s93, s93, s92
  s_movk_i32 s67, 0x1e0
  v_and_or_b32 v6, v5, s67, v1
  ds_read_b128 v[28:31], v6
  s_cmp_eq_u32 s92, s65
  s_cbranch_scc1 K2_ATOK
  s_lshl_b32 s67, s92, 4
  s_mul_i32 s68, s53, 2560
  s_add_u32 s67, s67, s68
  s_add_u32 s67, s67, 105472
  v_mul_u32_u24 v6, 20, v2
  v_add3_u32 v6, v6, v1, s67
  ds_read_b128 v[16:19], v6
  ds_read_b128 v[20:23], v6 offset:2560
  s_mov_b32 s65, s92
  s_mov_b32 s67, 0x05040100
  s_mov_b32 s68, 0x07060100
  s_waitcnt lgkmcnt(0)
  s_mov_b32 exec_lo, 0
  v_perm_b32 v19, v3, v19, s67
  v_perm_b32 v23, v3, v23, s68
  s_mov_b64 exec, -1
K2_ATOK:
  s_waitcnt vmcnt(0)
  v_lshlrev_b32 v60, 16, v44
  v_lshlrev_b32 v61, 16, v45
  v_lshlrev_b32 v62, 16, v46
  v_lshlrev_b32 v63, 16, v47
  v_lshlrev_b32 v64, 16, v48
  v_lshlrev_b32 v65, 16, v49
  v_lshlrev_b32 v66, 16, v50
  v_lshlrev_b32 v67, 16, v51
  v_lshlrev_b32 v68, 16, v52
  v_lshlrev_b32 v69, 16, v53
  v_lshlrev_b32 v70, 16, v54
  v_lshlrev_b32 v71, 16, v55
  v_lshlrev_b32 v72, 16, v56
  v_lshlrev_b32 v73, 16, v57
  v_lshlrev_b32 v74, 16, v58
  v_lshlrev_b32 v75, 16, v59
  s_waitcnt lgkmcnt(0)
  s_mov_b32 s67, 0xffff0000
  s_mov_b32 exec_lo, 0
  v_and_or_b32 v31, v5, s67, v31
  s_mov_b64 exec, -1
  v_mfma_f32_32x32x16_bf16 v[76:91], v[24:27], v[12:15], v[44:59]
  v_mfma_f32_32x32x16_bf16 v[60:75], v[24:27], v[8:11], v[60:75]
  v_mfma_f32_32x32x16_bf16 v[76:91], v[28:31], v[20:23], v[76:91]
  v_mfma_f32_32x32x16_bf16 v[60:75], v[28:31], v[16:19], v[60:75]
  s_add_u32 s94, s62, 1
  s_nop 3
  s_lshl_b32 s67, s94, 7
  s_add_u32 s68, s67, 146432
  v_lshl_add_u32 v6, v1, 2, s68
  ds_read_b128 v[44:47], v6 offset:0
  ds_read_b128 v[48:51], v6 offset:16
  ds_read_b128 v[52:55], v6 offset:32
  ds_read_b128 v[56:59], v6 offset:48
  s_lshl_b32 s68, s94, 8
  v_add_u32 v7, s68, v4
  ds_read_b64 v[6:7], v7
  s_lshl_b32 s67, s62, 11
  v_add_u32 v43, s67, v0
  ds_read_b128 v[32:35], v43
  ds_read_b128 v[28:31], v43 offset:512
  v_exp_f32 v36, v76
  v_exp_f32 v37, v77
  v_exp_f32 v38, v78
  v_exp_f32 v39, v79
  v_exp_f32 v40, v80
  v_exp_f32 v41, v81
  v_exp_f32 v42, v82
  v_exp_f32 v43, v83
  v_pk_add_f32 v[36:37], v[36:37], 1.0
  v_pk_add_f32 v[38:39], v[38:39], 1.0
  v_pk_add_f32 v[40:41], v[40:41], 1.0
  v_pk_add_f32 v[42:43], v[42:43], 1.0
  v_rcp_f32 v36, v36
  v_rcp_f32 v37, v37
  v_rcp_f32 v38, v38
  v_rcp_f32 v39, v39
  v_rcp_f32 v40, v40
  v_rcp_f32 v41, v41
  v_rcp_f32 v42, v42
  v_rcp_f32 v43, v43
  v_pk_mul_f32 v[36:37], v[36:37], v[76:77]
  v_pk_mul_f32 v[38:39], v[38:39], v[78:79]
  v_pk_mul_f32 v[40:41], v[40:41], v[80:81]
  v_pk_mul_f32 v[42:43], v[42:43], v[82:83]
  v_cvt_pk_bf16_f32 v76, v36, v37
  v_cvt_pk_bf16_f32 v77, v38, v39
  v_cvt_pk_bf16_f32 v78, v40, v41
  v_cvt_pk_bf16_f32 v79, v42, v43
  s_cmp_ge_u32 s94, s63
  s_cbranch_scc1 K2_NONEXT
  s_waitcnt lgkmcnt(2)
  v_pk_add_f32 v[44:45], v[44:45], v[2:3] op_sel_hi:[1,0]
  v_pk_add_f32 v[46:47], v[46:47], v[2:3] op_sel_hi:[1,0]
  v_pk_add_f32 v[48:49], v[48:49], v[2:3] op_sel_hi:[1,0]
  v_pk_add_f32 v[50:51], v[50:51], v[2:3] op_sel_hi:[1,0]
  v_pk_add_f32 v[52:53], v[52:53], v[2:3] op_sel_hi:[1,0]
  v_pk_add_f32 v[54:55], v[54:55], v[2:3] op_sel_hi:[1,0]
  v_pk_add_f32 v[56:57], v[56:57], v[2:3] op_sel_hi:[1,0]
  v_pk_add_f32 v[58:59], v[58:59], v[2:3] op_sel_hi:[1,0]
  v_add_u32 v6, v6, v1
  v_mov_b32 v5, v7
  buffer_load_dwordx4 v[24:27], v6, s[32:35], 0 offen
  buffer_load_dword v44, v44, s[36:39], 0 offen
  buffer_load_dword v45, v45, s[36:39], 0 offen
  buffer_load_dword v46, v46, s[36:39], 0 offen
  buffer_load_dword v47, v47, s[36:39], 0 offen
  buffer_load_dword v48, v48, s[36:39], 0 offen
  buffer_load_dword v49, v49, s[36:39], 0 offen
  buffer_load_dword v50, v50, s[36:39], 0 offen
  buffer_load_dword v51, v51, s[36:39], 0 offen
  buffer_load_dword v52, v52, s[36:39], 0 offen
  buffer_load_dword v53, v53, s[36:39], 0 offen
  buffer_load_dword v54, v54, s[36:39], 0 offen
  buffer_load_dword v55, v55, s[36:39], 0 offen
  buffer_load_dword v56, v56, s[36:39], 0 offen
  buffer_load_dword v57, v57, s[36:39], 0 offen
  buffer_load_dword v58, v58, s[36:39], 0 offen
  buffer_load_dword v59, v59, s[36:39], 0 offen
  s_branch K2_NONEXT2
K2_NONEXT:
  s_cmp_eq_u32 s81, 0
  s_cbranch_scc1 K2_NONEXT2
  s_waitcnt lgkmcnt(2)
  v_mbcnt_lo_u32_b32 v6, -1, 0
  v_mbcnt_hi_u32_b32 v6, -1, v6
  v_lshlrev_b32 v6, 4, v6
  s_lshl_b32 s67, s52, 13
  s_add_u32 s67, s67, 16908288
  buffer_load_dwordx4 v[44:47], v6, s[40:43], s67 offen offset:0
  buffer_load_dwordx4 v[48:51], v6, s[40:43], s67 offen offset:1024
  buffer_load_dwordx4 v[52:55], v6, s[40:43], s67 offen offset:2048
  buffer_load_dwordx4 v[56:59], v6, s[40:43], s67 offen offset:3072
  s_add_u32 s67, s67, 4096
  buffer_load_dwordx4 v[8:11], v6, s[40:43], s67 offen offset:0
  buffer_load_dwordx4 v[12:15], v6, s[40:43], s67 offen offset:1024
  buffer_load_dwordx4 v[16:19], v6, s[40:43], s67 offen offset:2048
  buffer_load_dwordx4 v[20:23], v6, s[40:43], s67 offen offset:3072
  s_mov_b32 s15, 1
K2_NONEXT2:
  v_exp_f32 v36, v84
  v_exp_f32 v37, v85
  v_exp_f32 v38, v86
  v_exp_f32 v39, v87
  v_exp_f32 v40, v88
  v_exp_f32 v41, v89
  v_exp_f32 v42, v90
  v_exp_f32 v43, v91
  v_pk_add_f32 v[36:37], v[36:37], 1.0
  v_pk_add_f32 v[38:39], v[38:39], 1.0
  v_pk_add_f32 v[40:41], v[40:41], 1.0
  v_pk_add_f32 v[42:43], v[42:43], 1.0
  v_rcp_f32 v36, v36
  v_rcp_f32 v37, v37
  v_rcp_f32 v38, v38
  v_rcp_f32 v39, v39
  v_rcp_f32 v40, v40
  v_rcp_f32 v41, v41
  v_rcp_f32 v42, v42
  v_rcp_f32 v43, v43
  v_pk_mul_f32 v[36:37], v[36:37], v[84:85]
  v_pk_mul_f32 v[38:39], v[38:39], v[86:87]
  v_pk_mul_f32 v[40:41], v[40:41], v[88:89]
  v_pk_mul_f32 v[42:43], v[42:43], v[90:91]
  v_cvt_pk_bf16_f32 v80, v36, v37
  v_cvt_pk_bf16_f32 v81, v38, v39
  v_cvt_pk_bf16_f32 v82, v40, v41
  v_cvt_pk_bf16_f32 v83, v42, v43
  v_exp_f32 v36, v60
  v_exp_f32 v37, v61
  v_exp_f32 v38, v62
  v_exp_f32 v39, v63
  v_exp_f32 v40, v64
  v_exp_f32 v41, v65
  v_exp_f32 v42, v66
  v_exp_f32 v43, v67
  v_pk_add_f32 v[36:37], v[36:37], 1.0
  v_pk_add_f32 v[38:39], v[38:39], 1.0
  v_pk_add_f32 v[40:41], v[40:41], 1.0
  v_pk_add_f32 v[42:43], v[42:43], 1.0
  v_rcp_f32 v36, v36
  v_rcp_f32 v37, v37
  v_rcp_f32 v38, v38
  v_rcp_f32 v39, v39
  v_rcp_f32 v40, v40
  v_rcp_f32 v41, v41
  v_rcp_f32 v42, v42
  v_rcp_f32 v43, v43
  v_pk_mul_f32 v[36:37], v[36:37], v[60:61]
  v_pk_mul_f32 v[38:39], v[38:39], v[62:63]
  v_pk_mul_f32 v[40:41], v[40:41], v[64:65]
  v_pk_mul_f32 v[42:43], v[42:43], v[66:67]
  v_cvt_pk_bf16_f32 v60, v36, v37
  v_cvt_pk_bf16_f32 v61, v38, v39
  v_cvt_pk_bf16_f32 v62, v40, v41
  v_cvt_pk_bf16_f32 v63, v42, v43
  v_exp_f32 v36, v68
  v_exp_f32 v37, v69
  v_exp_f32 v38, v70
  v_exp_f32 v39, v71
  v_exp_f32 v40, v72
  v_exp_f32 v41, v73
  v_exp_f32 v42, v74
  v_exp_f32 v43, v75
  v_pk_add_f32 v[36:37], v[36:37], 1.0
  v_pk_add_f32 v[38:39], v[38:39], 1.0
  v_pk_add_f32 v[40:41], v[40:41], 1.0
  v_pk_add_f32 v[42:43], v[42:43], 1.0
  v_rcp_f32 v36, v36
  v_rcp_f32 v37, v37
  v_rcp_f32 v38, v38
  v_rcp_f32 v39, v39
  v_rcp_f32 v40, v40
  v_rcp_f32 v41, v41
  v_rcp_f32 v42, v42
  v_rcp_f32 v43, v43
  v_pk_mul_f32 v[36:37], v[36:37], v[68:69]
  v_pk_mul_f32 v[38:39], v[38:39], v[70:71]
  v_pk_mul_f32 v[40:41], v[40:41], v[72:73]
  v_pk_mul_f32 v[42:43], v[42:43], v[74:75]
  v_cvt_pk_bf16_f32 v64, v36, v37
  v_cvt_pk_bf16_f32 v65, v38, v39
  v_cvt_pk_bf16_f32 v66, v40, v41
  v_cvt_pk_bf16_f32 v67, v42, v43
  s_mov_b32 s96, s92
K2_PASS:
  s_cmp_eq_u32 s96, s64
  s_cbranch_scc1 K2_ACC
  s_cmp_lt_i32 s64, 0
  s_cbranch_scc1 K2_NOFL
  s_lshl_b32 s67, s53, 7
  s_add_u32 s67, s67, 155648
  v_add_u32 v6, s67, v1
  ds_read_b128 v[68:71], v6 offset:0
  ds_read_b128 v[72:75], v6 offset:32
  ds_read_b128 v[84:87], v6 offset:64
  ds_read_b128 v[88:91], v6 offset:96
  s_lshl_b32 s67, s64, 3
  s_mov_b32 s68, s64
  s_cmp_eq_u32 s64, s89
  s_cbranch_scc0 K2_F1A
  s_cmp_eq_u32 s80, 0
  s_cbranch_scc1 K2_F1A
  s_lshl_b32 s67, s54, 3
  s_add_u32 s67, s67, 32
  s_add_u32 s68, s54, 4
K2_F1A:
  s_mul_i32 s67, s67, 544
  s_lshl_b32 s69, s53, 7
  s_add_u32 s67, s67, s69
  s_add_u32 s67, s67, 66048
  v_bfe_u32 v6, v2, 4, 3
  v_mul_u32_u24 v6, 544, v6
  v_lshrrev_b32 v36, 1, v1
  v_add3_u32 v6, v6, v36, s67
  v_cvt_pk_bf16_f32 v92, v92, v93
  v_cvt_pk_bf16_f32 v93, v94, v95
  v_cvt_pk_bf16_f32 v94, v96, v97
  v_cvt_pk_bf16_f32 v95, v98, v99
  v_cvt_pk_bf16_f32 v96, v100, v101
  v_cvt_pk_bf16_f32 v97, v102, v103
  v_cvt_pk_bf16_f32 v98, v104, v105
  v_cvt_pk_bf16_f32 v99, v106, v107
  v_cvt_pk_bf16_f32 v123, v122, v123
  v_cvt_pk_bf16_f32 v122, v120, v121
  v_cvt_pk_bf16_f32 v121, v118, v119
  v_cvt_pk_bf16_f32 v120, v116, v117
  v_cvt_pk_bf16_f32 v119, v114, v115
  v_cvt_pk_bf16_f32 v118, v112, v113
  v_cvt_pk_bf16_f32 v117, v110, v111
  v_cvt_pk_bf16_f32 v116, v108, v109
  s_waitcnt lgkmcnt(0)
  v_mfma_f32_32x32x16_bf16 v[100:115], v[68:71], v[92:95], 0
  v_mfma_f32_32x32x16_bf16 v[100:115], v[72:75], v[96:99], v[100:115]
  v_mfma_f32_32x32x16_bf16 v[100:115], v[84:87], v[116:119], v[100:115]
  v_mfma_f32_32x32x16_bf16 v[100:115], v[88:91], v[120:123], v[100:115]
  s_mov_b32 exec_lo, 0x11111111
  s_mov_b32 exec_hi, 0x11111111
  s_cmp_eq_u32 s80, 0
  s_cbranch_scc1 K2_F1B
  ds_write_b64 v6, v[92:93] offset:0
  ds_write_b64 v6, v[116:117] offset:64
  ds_write_b64 v6, v[94:95] offset:16
  ds_write_b64 v6, v[118:119] offset:80
  ds_write_b64 v6, v[96:97] offset:32
  ds_write_b64 v6, v[120:121] offset:96
  ds_write_b64 v6, v[98:99] offset:48
  ds_write_b64 v6, v[122:123] offset:112
  s_branch K2_F1C
K2_F1B:
  ds_pk_add_bf16 v6, v92 offset:0
  ds_pk_add_bf16 v6, v116 offset:64
  ds_pk_add_bf16 v6, v93 offset:4
  ds_pk_add_bf16 v6, v117 offset:68
  ds_pk_add_bf16 v6, v94 offset:16
  ds_pk_add_bf16 v6, v118 offset:80
  ds_pk_add_bf16 v6, v95 offset:20
  ds_pk_add_bf16 v6, v119 offset:84
  ds_pk_add_bf16 v6, v96 offset:32
  ds_pk_add_bf16 v6, v120 offset:96
  ds_pk_add_bf16 v6, v97 offset:36
  ds_pk_add_bf16 v6, v121 offset:100
  ds_pk_add_bf16 v6, v98 offset:48
  ds_pk_add_bf16 v6, v122 offset:112
  ds_pk_add_bf16 v6, v99 offset:52
  ds_pk_add_bf16 v6, v123 offset:116
K2_F1C:
  s_lshl_b32 s67, s68, 7
  s_mul_i32 s69, s53, 896
  s_add_u32 s67, s67, s69
  s_add_u32 s67, s67, 100864
  s_mov_b64 exec, 0xffffffff
  v_add_u32 v36, s67, v2
  s_cmp_eq_u32 s80, 0
  s_cbranch_scc1 K2_F1D
  ds_write_b32 v36, v100
  s_branch K2_F1E
K2_F1D:
  ds_add_f32 v36, v100
K2_F1E:
  s_mov_b64 exec, -1
K2_NOFL:
  s_mov_b32 s64, s96
  s_waitcnt lgkmcnt(0)
  v_mfma_f32_32x32x16_bf16 v[92:107], v[60:63], v[32:35], 0
  v_mfma_f32_32x32x16_bf16 v[108:123], v[76:79], v[32:35], 0
  s_branch K2_ACC2
K2_ACC:
  s_waitcnt lgkmcnt(0)
  v_mfma_f32_32x32x16_bf16 v[92:107], v[60:63], v[32:35], v[92:107]
  v_mfma_f32_32x32x16_bf16 v[108:123], v[76:79], v[32:35], v[108:123]
K2_ACC2:
  v_mfma_f32_32x32x16_bf16 v[92:107], v[64:67], v[28:31], v[92:107]
  v_mfma_f32_32x32x16_bf16 v[108:123], v[80:83], v[28:31], v[108:123]
  s_cmp_eq_u32 s93, 0
  s_cbranch_scc1 K2_NEXT
  s_mov_b32 s93, 0
  s_add_u32 s96, s92, 1
  s_add_u32 s67, s92, 24
  s_lshl_b32 s67, s67, 11
  v_add_u32 v43, s67, v0
  s_nop 7
  ds_read_b128 v[32:35], v43
  ds_read_b128 v[28:31], v43 offset:512
  s_branch K2_PASS
K2_NEXT:
  s_add_u32 s62, s62, 1
  s_cmp_lt_u32 s62, s63
  s_cbranch_scc1 K2_LOOP
  s_mov_b32 s14, 0
  s_cmp_eq_u32 s81, 0
  s_cbranch_scc1 K2_NOF2
  s_nop 7
  v_mbcnt_lo_u32_b32 v6, -1, 0
  v_mbcnt_hi_u32_b32 v6, -1, v6
  v_lshlrev_b32 v6, 4, v6
  s_lshl_b32 s67, s52, 13
  s_add_u32 s67, s67, 17039360
  buffer_load_dwordx4 v[60:63], v6, s[40:43], s67 offen offset:0
  buffer_load_dwordx4 v[64:67], v6, s[40:43], s67 offen offset:1024
  buffer_load_dwordx4 v[68:71], v6, s[40:43], s67 offen offset:2048
  buffer_load_dwordx4 v[72:75], v6, s[40:43], s67 offen offset:3072
  s_add_u32 s67, s67, 4096
  buffer_load_dwordx4 v[76:79], v6, s[40:43], s67 offen offset:0
  buffer_load_dwordx4 v[80:83], v6, s[40:43], s67 offen offset:1024
  buffer_load_dwordx4 v[84:87], v6, s[40:43], s67 offen offset:2048
  buffer_load_dwordx4 v[88:91], v6, s[40:43], s67 offen offset:3072
  s_mov_b32 s14, 2
K2_NOF2:
  s_nop 3
  s_lshl_b32 s67, s53, 7
  s_add_u32 s67, s67, 155648
  v_add_u32 v6, s67, v1
  ds_read_b128 v[36:39], v6 offset:0
  ds_read_b128 v[40:43], v6 offset:32
  ds_read_b128 v[28:31], v6 offset:64
  ds_read_b128 v[32:35], v6 offset:96
  s_lshl_b32 s67, s64, 3
  s_mov_b32 s68, s64
  s_cmp_eq_u32 s64, s89
  s_cbranch_scc0 K2_F2A
  s_cmp_eq_u32 s80, 0
  s_cbranch_scc1 K2_F2A
  s_lshl_b32 s67, s54, 3
  s_add_u32 s67, s67, 32
  s_add_u32 s68, s54, 4
K2_F2A:
  s_mul_i32 s67, s67, 544
  s_lshl_b32 s69, s53, 7
  s_add_u32 s67, s67, s69
  s_add_u32 s67, s67, 66048
  v_bfe_u32 v6, v2, 4, 3
  v_mul_u32_u24 v6, 544, v6
  v_lshrrev_b32 v7, 1, v1
  v_add3_u32 v6, v6, v7, s67
  v_cvt_pk_bf16_f32 v92, v92, v93
  v_cvt_pk_bf16_f32 v93, v94, v95
  v_cvt_pk_bf16_f32 v94, v96, v97
  v_cvt_pk_bf16_f32 v95, v98, v99
  v_cvt_pk_bf16_f32 v96, v100, v101
  v_cvt_pk_bf16_f32 v97, v102, v103
  v_cvt_pk_bf16_f32 v98, v104, v105
  v_cvt_pk_bf16_f32 v99, v106, v107
  v_cvt_pk_bf16_f32 v123, v122, v123
  v_cvt_pk_bf16_f32 v122, v120, v121
  v_cvt_pk_bf16_f32 v121, v118, v119
  v_cvt_pk_bf16_f32 v120, v116, v117
  v_cvt_pk_bf16_f32 v119, v114, v115
  v_cvt_pk_bf16_f32 v118, v112, v113
  v_cvt_pk_bf16_f32 v117, v110, v111
  v_cvt_pk_bf16_f32 v116, v108, v109
  s_waitcnt lgkmcnt(0)
  v_mfma_f32_32x32x16_bf16 v[100:115], v[36:39], v[92:95], 0
  v_mfma_f32_32x32x16_bf16 v[100:115], v[40:43], v[96:99], v[100:115]
  v_mfma_f32_32x32x16_bf16 v[100:115], v[28:31], v[116:119], v[100:115]
  v_mfma_f32_32x32x16_bf16 v[100:115], v[32:35], v[120:123], v[100:115]
  s_mov_b32 exec_lo, 0x11111111
  s_mov_b32 exec_hi, 0x11111111
  s_cmp_eq_u32 s80, 0
  s_cbranch_scc1 K2_F2B
  ds_write_b64 v6, v[92:93] offset:0
  ds_write_b64 v6, v[116:117] offset:64
  ds_write_b64 v6, v[94:95] offset:16
  ds_write_b64 v6, v[118:119] offset:80
  ds_write_b64 v6, v[96:97] offset:32
  ds_write_b64 v6, v[120:121] offset:96
  ds_write_b64 v6, v[98:99] offset:48
  ds_write_b64 v6, v[122:123] offset:112
  s_branch K2_F2C
K2_F2B:
  ds_pk_add_bf16 v6, v92 offset:0
  ds_pk_add_bf16 v6, v116 offset:64
  ds_pk_add_bf16 v6, v93 offset:4
  ds_pk_add_bf16 v6, v117 offset:68
  ds_pk_add_bf16 v6, v94 offset:16
  ds_pk_add_bf16 v6, v118 offset:80
  ds_pk_add_bf16 v6, v95 offset:20
  ds_pk_add_bf16 v6, v119 offset:84
  ds_pk_add_bf16 v6, v96 offset:32
  ds_pk_add_bf16 v6, v120 offset:96
  ds_pk_add_bf16 v6, v97 offset:36
  ds_pk_add_bf16 v6, v121 offset:100
  ds_pk_add_bf16 v6, v98 offset:48
  ds_pk_add_bf16 v6, v122 offset:112
  ds_pk_add_bf16 v6, v99 offset:52
  ds_pk_add_bf16 v6, v123 offset:116
K2_F2C:
  s_lshl_b32 s67, s68, 7
  s_mul_i32 s69, s53, 896
  s_add_u32 s67, s67, s69
  s_add_u32 s67, s67, 100864
  s_mov_b64 exec, 0xffffffff
  v_add_u32 v7, s67, v2
  s_cmp_eq_u32 s80, 0
  s_cbranch_scc1 K2_F2D
  ds_write_b32 v7, v100
  s_branch K2_F2E
K2_F2D:
  ds_add_f32 v7, v100
K2_F2E:
  s_mov_b64 exec, -1
K2_LOOPEND:
  s_setprio 0
  s_cmp_eq_u32 s80, 0
  s_cbranch_scc1 K2_NOSAVE
  s_mov_b32 s8, s56
  s_mov_b32 s9, s57
  s_mov_b32 s10, s58
  s_mov_b32 s11, s59
  s_mov_b32 s12, s95
  s_mov_b32 s5, s4
K2_NOSAVE:
  s_mov_b32 s80, 0
  s_cmp_lg_u32 s81, 0
  s_cbranch_scc1 K2_EPI
  s_waitcnt vmcnt(0) lgkmcnt(0)
  s_add_u32 s66, s66, 24
  s_cmp_lt_u32 s66, s61
  s_cbranch_scc0 K2_OVNEXT
  s_barrier
  s_branch K2_ROUND
K2_OVNEXT:
  s_lshl_b32 s55, s84, 11
  s_cmp_lt_u32 s55, s85
  s_cbranch_scc1 K2_OVGO
  s_cmp_eq_u64 s[82:83], 0
  s_cbranch_scc1 K2_EPI
  s_ff1_i32_b64 s86, s[82:83]
  s_bitset0_b64 s[82:83], s86
  s_lshl_b32 s55, s86, 2
  s_add_u32 s55, s55, 13500416
  v_mov_b32 v100, 0
  buffer_load_dword v100, v100, s[40:43], s55 offen
  s_waitcnt vmcnt(0)
  v_readfirstlane_b32 s85, v100
  s_nop 0
  s_min_u32 s85, s85, 2500
  s_mov_b32 s84, 0
  s_branch K2_OVNEXT
K2_OVGO:
  s_mov_b32 s69, s55
  s_barrier
  v_mbcnt_lo_u32_b32 v126, -1, 0
  v_mbcnt_hi_u32_b32 v126, -1, v126
  s_lshl_b32 s55, s52, 6
  v_add_u32 v122, s55, v126
  s_mul_i32 s87, s86, 40000
  s_add_u32 s87, s87, 13631488
  s_lshl_b32 s67, s69, 4
  s_add_u32 s87, s87, s67
  s_add_u32 s88, s87, 16384
  s_add_u32 s84, s84, 1
  s_cmp_ge_u32 s52, 8
  s_cbranch_scc1 K2_OVG2
  v_lshlrev_b32 v121, 4, v122
  v_add_u32 v120, 8192, v121
  buffer_load_dwordx4 v[100:103], v121, s[40:43], s87 offen
  buffer_load_dwordx4 v[104:107], v120, s[40:43], s87 offen
  buffer_load_dwordx4 v[108:111], v121, s[40:43], s88 offen
  buffer_load_dwordx4 v[112:115], v120, s[40:43], s88 offen
  v_lshlrev_b32 v120, 2, v122
  v_add_u32 v120, 104960, v120
  v_mov_b32 v121, 0
  v_cmp_gt_u32 vcc, 40, v122
  s_nop 0
  s_and_saveexec_b64 s[70:71], vcc
  ds_write_b32 v120, v121
  s_mov_b64 exec, s[70:71]
  s_waitcnt vmcnt(0) lgkmcnt(0)
  v_add_u32 v120, s69, v122
  v_cmp_gt_u32 s[76:77], s85, v120
  v_and_b32 v121, 0xff, v100
  v_cmp_eq_u32 vcc, s2, v121
  s_nop 0
  s_and_b64 s[76:77], s[76:77], vcc
  v_add_u32 v120, s69, v122
  v_add_u32 v120, 512, v120
  v_cmp_gt_u32 s[78:79], s85, v120
  v_and_b32 v121, 0xff, v104
  v_cmp_eq_u32 vcc, s2, v121
  s_nop 0
  s_and_b64 s[78:79], s[78:79], vcc
  v_add_u32 v120, s69, v122
  v_add_u32 v120, 1024, v120
  v_cmp_gt_u32 s[16:17], s85, v120
  v_and_b32 v121, 0xff, v108
  v_cmp_eq_u32 vcc, s2, v121
  s_nop 0
  s_and_b64 s[16:17], s[16:17], vcc
  v_add_u32 v120, s69, v122
  v_add_u32 v120, 1536, v120
  v_cmp_gt_u32 s[18:19], s85, v120
  v_and_b32 v121, 0xff, v112
  v_cmp_eq_u32 vcc, s2, v121
  s_nop 0
  s_and_b64 s[18:19], s[18:19], vcc
K2_OVG2:
  s_barrier
  s_branch K2_BATCH
K2_EPI:
  v_mbcnt_lo_u32_b32 v126, -1, 0
  v_mbcnt_hi_u32_b32 v126, -1, v126
  s_lshl_b32 s55, s52, 6
  v_add_u32 v122, s55, v126
  v_lshlrev_b32 v123, 4, v126
  s_cmp_lg_u32 s15, 0
  s_cbranch_scc1 K2_F1OK
  s_lshl_b32 s67, s52, 13
  s_add_u32 s67, s67, 16908288
  buffer_load_dwordx4 v[44:47], v123, s[40:43], s67 offen offset:0
  buffer_load_dwordx4 v[48:51], v123, s[40:43], s67 offen offset:1024
  buffer_load_dwordx4 v[52:55], v123, s[40:43], s67 offen offset:2048
  buffer_load_dwordx4 v[56:59], v123, s[40:43], s67 offen offset:3072
  s_add_u32 s67, s67, 4096
  buffer_load_dwordx4 v[8:11], v123, s[40:43], s67 offen offset:0
  buffer_load_dwordx4 v[12:15], v123, s[40:43], s67 offen offset:1024
  buffer_load_dwordx4 v[16:19], v123, s[40:43], s67 offen offset:2048
  buffer_load_dwordx4 v[20:23], v123, s[40:43], s67 offen offset:3072
K2_F1OK:
  s_cmp_eq_u32 s14, 2
  s_cbranch_scc1 K2_F2OK
  s_lshl_b32 s67, s52, 13
  s_add_u32 s67, s67, 17039360
  buffer_load_dwordx4 v[60:63], v123, s[40:43], s67 offen offset:0
  buffer_load_dwordx4 v[64:67], v123, s[40:43], s67 offen offset:1024
  buffer_load_dwordx4 v[68:71], v123, s[40:43], s67 offen offset:2048
  buffer_load_dwordx4 v[72:75], v123, s[40:43], s67 offen offset:3072
  s_add_u32 s67, s67, 4096
  buffer_load_dwordx4 v[76:79], v123, s[40:43], s67 offen offset:0
  buffer_load_dwordx4 v[80:83], v123, s[40:43], s67 offen offset:1024
  buffer_load_dwordx4 v[84:87], v123, s[40:43], s67 offen offset:2048
  buffer_load_dwordx4 v[88:91], v123, s[40:43], s67 offen offset:3072
K2_F2OK:
  v_and_b32 v116, 15, v126
  v_lshrrev_b32 v117, 4, v126
  v_xor_b32 v118, v116, v117
  v_lshlrev_b32 v118, 4, v118
  v_lshl_add_u32 v118, v116, 9, v118
  v_add_u32 v118, 125952, v118
  v_mul_u32_u24 v119, 544, v116
  v_lshl_add_u32 v119, v117, 4, v119
  v_add_u32 v119, 66048, v119
  v_xor_b32 v120, 0, v118
  ds_read_b128 v[92:95], v120 offset:0
  ds_read_b128 v[96:99], v120 offset:8192
  ds_read_b128 v[100:103], v120 offset:16384
  v_xor_b32 v120, 64, v118
  ds_read_b128 v[24:27], v120 offset:0
  ds_read_b128 v[28:31], v120 offset:8192
  ds_read_b128 v[32:35], v120 offset:16384
  v_xor_b32 v120, 128, v118
  ds_read_b128 v[36:39], v120 offset:0
  ds_read_b128 v[40:43], v120 offset:8192
  ds_read_b128 v[0:3], v120 offset:16384
  s_waitcnt lgkmcnt(6)
  s_waitcnt vmcnt(8)
  v_mfma_f32_16x16x32_bf16 v[104:107], v[44:47], v[92:95], 0
  v_mfma_f32_16x16x32_bf16 v[108:111], v[44:47], v[96:99], 0
  v_mfma_f32_16x16x32_bf16 v[112:115], v[44:47], v[100:103], 0
  v_xor_b32 v120, 192, v118
  ds_read_b128 v[92:95], v120 offset:0
  ds_read_b128 v[96:99], v120 offset:8192
  ds_read_b128 v[100:103], v120 offset:16384
  s_waitcnt lgkmcnt(6)
  v_mfma_f32_16x16x32_bf16 v[104:107], v[48:51], v[24:27], v[104:107]
  v_mfma_f32_16x16x32_bf16 v[108:111], v[48:51], v[28:31], v[108:111]
  v_mfma_f32_16x16x32_bf16 v[112:115], v[48:51], v[32:35], v[112:115]
  v_xor_b32 v120, 256, v118
  ds_read_b128 v[24:27], v120 offset:0
  ds_read_b128 v[28:31], v120 offset:8192
  ds_read_b128 v[32:35], v120 offset:16384
  s_waitcnt lgkmcnt(6)
  v_mfma_f32_16x16x32_bf16 v[104:107], v[52:55], v[36:39], v[104:107]
  v_mfma_f32_16x16x32_bf16 v[108:111], v[52:55], v[40:43], v[108:111]
  v_mfma_f32_16x16x32_bf16 v[112:115], v[52:55], v[0:3], v[112:115]
  v_xor_b32 v120, 320, v118
  ds_read_b128 v[36:39], v120 offset:0
  ds_read_b128 v[40:43], v120 offset:8192
  ds_read_b128 v[0:3], v120 offset:16384
  s_waitcnt lgkmcnt(6)
  v_mfma_f32_16x16x32_bf16 v[104:107], v[56:59], v[92:95], v[104:107]
  v_mfma_f32_16x16x32_bf16 v[108:111], v[56:59], v[96:99], v[108:111]
  v_mfma_f32_16x16x32_bf16 v[112:115], v[56:59], v[100:103], v[112:115]
  v_xor_b32 v120, 384, v118
  ds_read_b128 v[92:95], v120 offset:0
  ds_read_b128 v[96:99], v120 offset:8192
  ds_read_b128 v[100:103], v120 offset:16384
  s_waitcnt lgkmcnt(6)
  v_mfma_f32_16x16x32_bf16 v[104:107], v[8:11], v[24:27], v[104:107]
  v_mfma_f32_16x16x32_bf16 v[108:111], v[8:11], v[28:31], v[108:111]
  v_mfma_f32_16x16x32_bf16 v[112:115], v[8:11], v[32:35], v[112:115]
  v_xor_b32 v120, 448, v118
  ds_read_b128 v[24:27], v120 offset:0
  ds_read_b128 v[28:31], v120 offset:8192
  ds_read_b128 v[32:35], v120 offset:16384
  s_waitcnt lgkmcnt(6)
  v_mfma_f32_16x16x32_bf16 v[104:107], v[12:15], v[36:39], v[104:107]
  v_mfma_f32_16x16x32_bf16 v[108:111], v[12:15], v[40:43], v[108:111]
  v_mfma_f32_16x16x32_bf16 v[112:115], v[12:15], v[0:3], v[112:115]
  s_waitcnt lgkmcnt(3)
  v_mfma_f32_16x16x32_bf16 v[104:107], v[16:19], v[92:95], v[104:107]
  v_mfma_f32_16x16x32_bf16 v[108:111], v[16:19], v[96:99], v[108:111]
  v_mfma_f32_16x16x32_bf16 v[112:115], v[16:19], v[100:103], v[112:115]
  s_waitcnt lgkmcnt(0)
  v_mfma_f32_16x16x32_bf16 v[104:107], v[20:23], v[24:27], v[104:107]
  v_mfma_f32_16x16x32_bf16 v[108:111], v[20:23], v[28:31], v[108:111]
  v_mfma_f32_16x16x32_bf16 v[112:115], v[20:23], v[32:35], v[112:115]
  s_barrier
  v_lshrrev_b32 v120, 7, v122
  v_mul_u32_u24 v120, 544, v120
  v_and_b32 v121, 127, v122
  v_lshl_add_u32 v120, v121, 2, v120
  v_add_u32 v120, 66048, v120
  s_mov_b32 s58, 0xffff0000
  s_mul_i32 s55, s12, 32
  s_mov_b32 s56, 0
  s_cmp_ge_u32 s55, s8
  s_addc_u32 s56, s56, 0
  s_cmp_ge_u32 s55, s9
  s_addc_u32 s56, s56, 0
  s_cmp_ge_u32 s55, s10
  s_addc_u32 s56, s56, 0
  s_cmp_ge_u32 s55, s11
  s_addc_u32 s56, s56, 0
  s_mov_b32 s60, s56
  s_mul_i32 s57, s56, 4352
  v_add_u32 v25, s57, v120
  ds_read_b32 v29, v25
  ds_read_b32 v33, v120 offset:21760
  s_mul_i32 s55, s12, 64
  s_mov_b32 s56, 0
  s_cmp_ge_u32 s55, s8
  s_addc_u32 s56, s56, 0
  s_cmp_ge_u32 s55, s9
  s_addc_u32 s56, s56, 0
  s_cmp_ge_u32 s55, s10
  s_addc_u32 s56, s56, 0
  s_cmp_ge_u32 s55, s11
  s_addc_u32 s56, s56, 0
  s_mov_b32 s61, s56
  s_mul_i32 s57, s56, 4352
  v_add_u32 v26, s57, v120
  ds_read_b32 v30, v26
  ds_read_b32 v34, v120 offset:26112
  s_lshl_b32 s55, s12, 1
  s_add_u32 s55, s55, s5
  s_lshl_b32 s55, s55, 5
  s_mov_b32 s56, 0
  s_cmp_ge_u32 s55, s8
  s_addc_u32 s56, s56, 0
  s_cmp_ge_u32 s55, s9
  s_addc_u32 s56, s56, 0
  s_cmp_ge_u32 s55, s10
  s_addc_u32 s56, s56, 0
  s_cmp_ge_u32 s55, s11
  s_addc_u32 s56, s56, 0
  s_mov_b32 s62, s56
  s_mul_i32 s57, s56, 4352
  v_add_u32 v27, s57, v120
  ds_read_b32 v31, v27
  ds_read_b32 v35, v120 offset:30464
  s_waitcnt lgkmcnt(0)
  v_lshlrev_b32 v36, 16, v29
  v_and_b32 v37, s58, v29
  v_lshlrev_b32 v38, 16, v33
  v_and_b32 v39, s58, v33
  v_add_f32 v36, v36, v38
  v_add_f32 v37, v37, v39
  v_cvt_pk_bf16_f32 v40, v36, v37
  ds_write_b32 v25, v40
  s_cmp_eq_u32 s61, s60
  s_cbranch_scc1 K2_FX2
  v_lshlrev_b32 v36, 16, v30
  v_and_b32 v37, s58, v30
K2_FX2:
  v_lshlrev_b32 v38, 16, v34
  v_and_b32 v39, s58, v34
  v_add_f32 v36, v36, v38
  v_add_f32 v37, v37, v39
  v_cvt_pk_bf16_f32 v40, v36, v37
  ds_write_b32 v26, v40
  s_cmp_eq_u32 s62, s61
  s_cbranch_scc1 K2_FX3
  v_lshlrev_b32 v36, 16, v31
  v_and_b32 v37, s58, v31
K2_FX3:
  v_lshlrev_b32 v38, 16, v35
  v_and_b32 v39, s58, v35
  v_add_f32 v36, v36, v38
  v_add_f32 v37, v37, v39
  v_cvt_pk_bf16_f32 v40, v36, v37
  ds_write_b32 v27, v40
  s_waitcnt lgkmcnt(0)
  s_barrier
  ds_read_b128 v[36:39], v119 offset:0
  ds_read_b128 v[40:43], v119 offset:8704
  ds_read_b128 v[0:3], v119 offset:17408
  ds_read_b128 v[92:95], v119 offset:64
  ds_read_b128 v[96:99], v119 offset:8768
  ds_read_b128 v[100:103], v119 offset:17472
  ds_read_b128 v[24:27], v119 offset:128
  ds_read_b128 v[28:31], v119 offset:8832
  ds_read_b128 v[32:35], v119 offset:17536
  s_waitcnt lgkmcnt(6)
  s_waitcnt vmcnt(0)
  v_mfma_f32_16x16x32_bf16 v[104:107], v[60:63], v[36:39], v[104:107]
  v_mfma_f32_16x16x32_bf16 v[108:111], v[60:63], v[40:43], v[108:111]
  v_mfma_f32_16x16x32_bf16 v[112:115], v[60:63], v[0:3], v[112:115]
  ds_read_b128 v[36:39], v119 offset:192
  ds_read_b128 v[40:43], v119 offset:8896
  ds_read_b128 v[0:3], v119 offset:17600
  s_waitcnt lgkmcnt(6)
  v_mfma_f32_16x16x32_bf16 v[104:107], v[64:67], v[92:95], v[104:107]
  v_mfma_f32_16x16x32_bf16 v[108:111], v[64:67], v[96:99], v[108:111]
  v_mfma_f32_16x16x32_bf16 v[112:115], v[64:67], v[100:103], v[112:115]
  ds_read_b128 v[92:95], v119 offset:256
  ds_read_b128 v[96:99], v119 offset:8960
  ds_read_b128 v[100:103], v119 offset:17664
  s_waitcnt lgkmcnt(6)
  v_mfma_f32_16x16x32_bf16 v[104:107], v[68:71], v[24:27], v[104:107]
  v_mfma_f32_16x16x32_bf16 v[108:111], v[68:71], v[28:31], v[108:111]
  v_mfma_f32_16x16x32_bf16 v[112:115], v[68:71], v[32:35], v[112:115]
  ds_read_b128 v[24:27], v119 offset:320
  ds_read_b128 v[28:31], v119 offset:9024
  ds_read_b128 v[32:35], v119 offset:17728
  s_waitcnt lgkmcnt(6)
  v_mfma_f32_16x16x32_bf16 v[104:107], v[72:75], v[36:39], v[104:107]
  v_mfma_f32_16x16x32_bf16 v[108:111], v[72:75], v[40:43], v[108:111]
  v_mfma_f32_16x16x32_bf16 v[112:115], v[72:75], v[0:3], v[112:115]
  ds_read_b128 v[36:39], v119 offset:384
  ds_read_b128 v[40:43], v119 offset:9088
  ds_read_b128 v[0:3], v119 offset:17792
  s_waitcnt lgkmcnt(6)
  v_mfma_f32_16x16x32_bf16 v[104:107], v[76:79], v[92:95], v[104:107]
  v_mfma_f32_16x16x32_bf16 v[108:111], v[76:79], v[96:99], v[108:111]
  v_mfma_f32_16x16x32_bf16 v[112:115], v[76:79], v[100:103], v[112:115]
  ds_read_b128 v[92:95], v119 offset:448
  ds_read_b128 v[96:99], v119 offset:9152
  ds_read_b128 v[100:103], v119 offset:17856
  s_waitcnt lgkmcnt(6)
  v_mfma_f32_16x16x32_bf16 v[104:107], v[80:83], v[24:27], v[104:107]
  v_mfma_f32_16x16x32_bf16 v[108:111], v[80:83], v[28:31], v[108:111]
  v_mfma_f32_16x16x32_bf16 v[112:115], v[80:83], v[32:35], v[112:115]
  s_waitcnt lgkmcnt(3)
  v_mfma_f32_16x16x32_bf16 v[104:107], v[84:87], v[36:39], v[104:107]
  v_mfma_f32_16x16x32_bf16 v[108:111], v[84:87], v[40:43], v[108:111]
  v_mfma_f32_16x16x32_bf16 v[112:115], v[84:87], v[0:3], v[112:115]
  s_waitcnt lgkmcnt(0)
  v_mfma_f32_16x16x32_bf16 v[104:107], v[88:91], v[92:95], v[104:107]
  v_mfma_f32_16x16x32_bf16 v[108:111], v[88:91], v[96:99], v[108:111]
  v_mfma_f32_16x16x32_bf16 v[112:115], v[88:91], v[100:103], v[112:115]
  s_lshl_b32 s55, s52, 1
  v_lshrrev_b32 v120, 1, v117
  v_add_u32 v120, s55, v120
  v_xor_b32 v120, v120, v116
  v_lshlrev_b32 v120, 4, v120
  v_lshl_add_u32 v120, v116, 9, v120
  v_and_b32 v121, 1, v117
  v_lshl_add_u32 v120, v121, 3, v120
  v_add_u32 v120, 125952, v120
  ds_read_b64 v[36:37], v120 offset:0
  ds_read_b64 v[38:39], v120 offset:8192
  ds_read_b64 v[40:41], v120 offset:16384
  s_mul_i32 s55, s2, 40
  s_lshl_b32 s55, s55, 9
  s_lshl_b32 s56, s52, 5
  s_add_u32 s55, s55, s56
  v_lshlrev_b32 v121, 9, v116
  v_lshl_add_u32 v121, v117, 3, v121
  s_mov_b32 s56, 3216550459
  s_mov_b32 s57, 0xffff0000
  s_waitcnt lgkmcnt(0)
  s_mov_b32 s66, 3216550459
  s_mov_b32 s67, 3216550459
  v_pk_mul_f32 v[8:9], v[104:105], s[66:67]
  v_pk_mul_f32 v[10:11], v[106:107], s[66:67]
  v_exp_f32 v8, v8
  v_exp_f32 v9, v9
  v_exp_f32 v10, v10
  v_exp_f32 v11, v11
  v_lshlrev_b32 v12, 16, v36
  v_and_b32 v13, s57, v36
  v_pk_add_f32 v[8:9], v[8:9], 1.0
  v_pk_add_f32 v[10:11], v[10:11], 1.0
  v_rcp_f32 v8, v8
  v_rcp_f32 v9, v9
  v_rcp_f32 v10, v10
  v_rcp_f32 v11, v11
  v_lshlrev_b32 v14, 16, v37
  v_and_b32 v15, s57, v37
  v_pk_fma_f32 v[8:9], v[8:9], v[104:105], v[12:13]
  v_pk_fma_f32 v[10:11], v[10:11], v[106:107], v[14:15]
  v_cvt_pk_bf16_f32 v16, v8, v9
  v_cvt_pk_bf16_f32 v17, v10, v11
  s_add_u32 s58, s55, 0
  buffer_store_dwordx2 v[16:17], v121, s[44:47], s58 offen
  v_pk_mul_f32 v[8:9], v[108:109], s[66:67]
  v_pk_mul_f32 v[10:11], v[110:111], s[66:67]
  v_exp_f32 v8, v8
  v_exp_f32 v9, v9
  v_exp_f32 v10, v10
  v_exp_f32 v11, v11
  v_lshlrev_b32 v12, 16, v38
  v_and_b32 v13, s57, v38
  v_pk_add_f32 v[8:9], v[8:9], 1.0
  v_pk_add_f32 v[10:11], v[10:11], 1.0
  v_rcp_f32 v8, v8
  v_rcp_f32 v9, v9
  v_rcp_f32 v10, v10
  v_rcp_f32 v11, v11
  v_lshlrev_b32 v14, 16, v39
  v_and_b32 v15, s57, v39
  v_pk_fma_f32 v[8:9], v[8:9], v[108:109], v[12:13]
  v_pk_fma_f32 v[10:11], v[10:11], v[110:111], v[14:15]
  v_cvt_pk_bf16_f32 v18, v8, v9
  v_cvt_pk_bf16_f32 v19, v10, v11
  s_add_u32 s58, s55, 8192
  buffer_store_dwordx2 v[18:19], v121, s[44:47], s58 offen
  v_pk_mul_f32 v[8:9], v[112:113], s[66:67]
  v_pk_mul_f32 v[10:11], v[114:115], s[66:67]
  v_exp_f32 v8, v8
  v_exp_f32 v9, v9
  v_exp_f32 v10, v10
  v_exp_f32 v11, v11
  v_lshlrev_b32 v12, 16, v40
  v_and_b32 v13, s57, v40
  v_pk_add_f32 v[8:9], v[8:9], 1.0
  v_pk_add_f32 v[10:11], v[10:11], 1.0
  v_rcp_f32 v8, v8
  v_rcp_f32 v9, v9
  v_rcp_f32 v10, v10
  v_rcp_f32 v11, v11
  v_lshlrev_b32 v14, 16, v41
  v_and_b32 v15, s57, v41
  v_pk_fma_f32 v[8:9], v[8:9], v[112:113], v[12:13]
  v_pk_fma_f32 v[10:11], v[10:11], v[114:115], v[14:15]
  v_cvt_pk_bf16_f32 v20, v8, v9
  v_cvt_pk_bf16_f32 v21, v10, v11
  v_cmp_gt_u32 vcc, 8, v116
  s_nop 0
  s_and_saveexec_b64 s[70:71], vcc
  s_add_u32 s58, s55, 16384
  buffer_store_dwordx2 v[20:21], v121, s[44:47], s58 offen
  s_mov_b64 exec, s[70:71]
  s_cmp_ge_u32 s52, 2
  s_cbranch_scc1 K2_END
  v_mbcnt_lo_u32_b32 v126, -1, 0
  v_mbcnt_hi_u32_b32 v126, -1, v126
  s_lshl_b32 s55, s52, 6
  v_add_u32 v8, s55, v126
  v_mul_u32_u24 v9, 0x5556, v8
  v_lshrrev_b32 v9, 16, v9
  v_mul_u32_u24 v10, 3, v9
  v_sub_u32 v10, v8, v10
  v_lshrrev_b32 v15, 3, v9
  v_and_b32 v16, 7, v9
  v_lshl_add_u32 v16, v16, 2, v10
  v_lshlrev_b32 v16, 2, v16
  v_add_u32 v16, 100868, v16
  v_lshl_add_u32 v11, v15, 7, v16
  ds_read_b32 v20, v11 offset:0
  ds_read_b32 v21, v11 offset:1024
  ds_read_b32 v22, v11 offset:2048
  ds_read_b32 v23, v11 offset:3072
  ds_read_b32 v24, v16 offset:640
  ds_read_b32 v25, v16 offset:1664
  ds_read_b32 v26, v16 offset:2688
  ds_read_b32 v27, v16 offset:3712
  ds_read_b32 v28, v16 offset:768
  ds_read_b32 v29, v16 offset:1792
  ds_read_b32 v30, v16 offset:2816
  ds_read_b32 v31, v16 offset:3840
  ds_read_b32 v32, v16 offset:896
  ds_read_b32 v33, v16 offset:1920
  ds_read_b32 v34, v16 offset:2944
  ds_read_b32 v35, v16 offset:3968
  s_mov_b32 s72, s6
  s_and_b32 s73, s7, 0xffff
  s_mov_b32 s74, 60000
  s_mov_b32 s75, 0x00020000
  s_mul_i32 s55, s2, 240
  v_lshlrev_b32 v13, 1, v8
  v_cmp_gt_u32 vcc, 120, v8
  s_nop 0
  s_and_saveexec_b64 s[70:71], vcc
  s_cbranch_execz K2_END
  buffer_load_ushort v14, v13, s[72:75], s55 offen
  s_waitcnt lgkmcnt(0)
  v_add_f32 v20, v20, v21
  v_add_f32 v22, v22, v23
  v_add_f32 v12, v20, v22
  v_add_f32 v24, v24, v25
  v_add_f32 v26, v26, v27
  v_add_f32 v24, v24, v26
  v_cmp_eq_u32 vcc, s60, v15
  s_nop 1
  v_cndmask_b32 v24, 0, v24, vcc
  v_add_f32 v12, v12, v24
  v_add_f32 v28, v28, v29
  v_add_f32 v30, v30, v31
  v_add_f32 v28, v28, v30
  v_cmp_eq_u32 vcc, s61, v15
  s_nop 1
  v_cndmask_b32 v28, 0, v28, vcc
  v_add_f32 v12, v12, v28
  v_add_f32 v32, v32, v33
  v_add_f32 v34, v34, v35
  v_add_f32 v32, v32, v34
  v_cmp_eq_u32 vcc, s62, v15
  s_nop 1
  v_cndmask_b32 v32, 0, v32, vcc
  v_add_f32 v12, v12, v32
  s_mov_b32 s56, 3207688728
  s_waitcnt vmcnt(0)
  v_lshlrev_b32 v14, 16, v14
  v_fma_f32 v14, v12, s56, v14
  v_cvt_pk_bf16_f32 v14, v14, v14
  s_add_u32 s55, s55, 5120000
  buffer_store_short v14, v13, s[44:47], s55 offen
K2_END:
  s_endpgm
.section .rodata,"a"
.p2align 6
.amdhsa_kernel egnn_k1_kernel
  .amdhsa_next_free_vgpr 128
  .amdhsa_next_free_sgpr 102
  .amdhsa_accum_offset 128
  .amdhsa_group_segment_fixed_size 0
  .amdhsa_kernarg_size 88
  .amdhsa_user_sgpr_count 2
  .amdhsa_user_sgpr_kernarg_segment_ptr 1
  .amdhsa_system_sgpr_workgroup_id_x 1
  .amdhsa_float_denorm_mode_32 3
.end_amdhsa_kernel
.p2align 6
.amdhsa_kernel egnn_k2_kernel
  .amdhsa_next_free_vgpr 128
  .amdhsa_next_free_sgpr 102
  .amdhsa_accum_offset 128
  .amdhsa_group_segment_fixed_size 0
  .amdhsa_kernarg_size 88
  .amdhsa_user_sgpr_count 2
  .amdhsa_user_sgpr_kernarg_segment_ptr 1
  .amdhsa_system_sgpr_workgroup_id_x 1
  .amdhsa_float_denorm_mode_32 3
.end_amdhsa_kernel
```
